```python
import torch

def _softmax(x, axis=-1):
    return torch.softmax(x, dim=axis)
def _gelu(x):
    return torch.nn.functional.gelu(x, approximate="tanh")
def _silu(x):
    return torch.nn.functional.silu(x)
def _sigmoid(x):
    return torch.sigmoid(x)
def _layernorm(x, axis=-1, eps=1e-5):
    m = x.mean(dim=axis, keepdim=True)
    v = x.var(dim=axis, keepdim=True, unbiased=False)
    return (x - m) / torch.sqrt(v + eps)
def _scatter_add(tgt, idx, src, axis=0):
    return tgt.clone().index_add_(axis, idx, src)
def _segment_sum(src, seg, n):
    out = torch.zeros((n,) + src.shape[1:], dtype=src.dtype)
    return out.index_add_(0, seg, src)
def _pad(x, pw):
    flat = tuple(v for pair in reversed(pw) for v in pair)
    return torch.nn.functional.pad(x, flat)

kernel_name = 'sequential_preLN__sliding_block__mixer_token_mlp__prompt'

def setup_inputs():

    _w = (lambda a: (lambda t: t.to(torch.bfloat16) if t.is_floating_point() else t)(torch.as_tensor(a)))
    def _A_setup():
        B, S, D = 1, 2048, 448
        return {
            "x": _w((lambda *s: torch.randn(*s, dtype=torch.bfloat16) * 0.05)(B, S, D)),
            "wqkv": _w((lambda *s: torch.randn(*s, dtype=torch.bfloat16) * 0.05)(D, 3 * D)),
            "wo": _w((lambda *s: torch.randn(*s, dtype=torch.bfloat16) * 0.05)(D, D)),
        }
    _A_in = _A_setup()

    def _B_setup():
        B, S, D, F = 1, 2048, 448, 1792
        return {
            "x": _w((lambda *s: torch.randn(*s, dtype=torch.bfloat16) * 0.05)(B, S, D)),
            "w1": _w((lambda *s: torch.randn(*s, dtype=torch.bfloat16) * 1.6)(S, F) * (S ** -0.5)),
            "b1": _w((lambda *s: torch.randn(*s, dtype=torch.bfloat16) * 1.6)(F) * 0.02),
            "w2": _w((lambda *s: torch.randn(*s, dtype=torch.bfloat16) * 0.2)(F, S) * (F ** -0.5)),
            "b2": _w((lambda *s: torch.randn(*s, dtype=torch.bfloat16) * 0.2)(S) * 0.02),
        }
    _B_in = _B_setup()

    return {
        "A_x": _A_in["x"],
        "A_wqkv": _A_in["wqkv"],
        "A_wo": _A_in["wo"],
        "B_x": _B_in["x"],
        "B_w1": _B_in["w1"],
        "B_b1": _B_in["b1"],
        "B_w2": _B_in["w2"],
        "B_b2": _B_in["b2"],
    }

def reference(A_x, A_wqkv, A_wo, B_x, B_w1, B_b1, B_w2, B_b2):
    def _A_ref(x, wqkv, wo):
        B, S, D = x.shape
        H = 16; Dh = D // H; W = 256
        qkv = (lambda x, *d: x.permute(*d))((x @ wqkv).reshape(B, S, 3, H, Dh), 2, 0, 3, 1, 4)
        q, k, v = qkv[0], qkv[1], qkv[2]
        scores = torch.einsum("bhqd,bhkd->bhqk", q, k) * (Dh ** -0.5)
        idx = torch.arange(S)
        mask = (idx[:, None] - idx[None, :] >= 0) & (idx[:, None] - idx[None, :] < W)
        scores = torch.where(mask[None, None], scores, -1e9)
        p = _softmax(scores, axis=-1)
        o = torch.einsum("bhqk,bhkd->bhqd", p, v)
        return (lambda x, *d: x.permute(*d))(o, 0, 2, 1, 3).reshape(B, S, D) @ wo

    def _B_ref(x, w1, b1, w2, b2):
        B, S, D = x.shape
        h = _layernorm(x, axis=-1)
        u = torch.einsum("bsd,sf->bdf", h, w1) + b1
        u = _gelu(u)
        y = torch.einsum("bdf,fs->bds", u, w2) + b2
        return (lambda x, *d: x.permute(*d))(y, 0, 2, 1)

    x = A_x
    h = x + _A_ref(_layernorm(x, axis=-1), A_wqkv, A_wo)
    h2 = h + _B_ref(_layernorm(h, axis=-1), B_w1, B_b1, B_w2, B_b2)
    return h2
```

```asm
; @launch grid=(256,1,1) block=(256,1,1) lds=163840
.amdgcn_target "amdgcn-amd-amdhsa--gfx950"
.text
.globl sequential_preLN__sliding_block__mixer_token_mlp__prompt_kernel
.p2align 8
.type sequential_preLN__sliding_block__mixer_token_mlp__prompt_kernel,@function
sequential_preLN__sliding_block__mixer_token_mlp__prompt_kernel:
    s_cmp_ge_u32 s2, 256
    s_cbranch_scc1 sequential_preLN__sliding_block__mixer_token_mlp__prompt_kernel_end
    s_load_dwordx16 s[4:19], s[0:1], 0
    s_load_dwordx4 s[20:23], s[0:1], 64
    s_load_dwordx2 s[24:25], s[0:1], 80
    v_lshrrev_b32 v2, 6, v0
    v_and_b32 v1, 63, v0
    v_readfirstlane_b32 s3, v2
    v_lshlrev_b32 v2, 4, v1
    s_and_b32 s27, s2, 7
    s_lshr_b32 s28, s2, 3
    s_lshr_b32 s29, s28, 1
    s_and_b32 s30, s28, 1
    s_lshl_b32 s48, s27, 1
    s_add_u32 s30, s30, s48
    s_lshl_b32 s31, s30, 2
    s_add_u32 s31, s31, s3
    v_lshrrev_b32 v3, 3, v1
    v_mul_u32_u24 v3, 896, v3
    v_and_b32 v4, 7, v1
    v_lshrrev_b32 v5, 4, v1
    v_xor_b32 v4, v4, v5
    v_lshl_add_u32 v10, v4, 4, v3
    v_xor_b32 v4, 4, v4
    v_lshl_add_u32 v11, v4, 4, v3
    v_add_u32 v12, 12288, v10
    v_add_u32 v13, 18432, v11
    v_add_u32 v11, 6144, v11
    v_lshrrev_b32 v3, 2, v1
    v_mul_u32_u24 v3, 2688, v3
    v_and_b32 v4, 3, v1
    v_lshl_add_u32 v14, v4, 4, v3
    s_mul_i32 s50, s31, 28672
    s_mul_i32 s51, s29, 56
    s_sub_u32 s52, 1204224, s51
    s_lshl_b32 s97, s3, 14
    s_mul_i32 s53, s3, 3264
    s_mul_i32 s54, s3, 43008
    s_waitcnt lgkmcnt(0)
    s_add_u32 s36, s4, s50
    s_addc_u32 s37, s5, 0
    s_mov_b32 s38, 28672
    s_mov_b32 s39, 0x20000
    s_add_u32 s40, s6, s51
    s_addc_u32 s41, s7, 0
    s_mov_b32 s42, s52
    s_mov_b32 s43, 0x20000
    s_add_u32 s10, s24, 1572876
    s_addc_u32 s11, s25, 0
    s_load_dword s26, s[10:11], 0
    s_add_u32 m0, s97, 0
    s_movk_i32 s48, 0
    buffer_load_dwordx4 v10, s[36:39], s48 offen offset:0 lds
    buffer_load_dwordx4 v11, s[36:39], s48 offen offset:1024 lds
    buffer_load_dwordx4 v12, s[36:39], s48 offen offset:2048 lds
    buffer_load_dwordx4 v13, s[36:39], s48 offen offset:3072 lds
    s_add_u32 m0, s53, 65536
    s_add_u32 s49, s54, 0
    buffer_load_dwordx4 v14, s[40:43], s49 offen lds
    s_add_u32 m0, s53, 66624
    s_add_u32 s49, s54, 896
    buffer_load_dwordx4 v14, s[40:43], s49 offen lds
    s_add_u32 m0, s53, 67712
    s_add_u32 s49, s54, 1792
    buffer_load_dwordx4 v14, s[40:43], s49 offen lds
    s_lshl_b32 s48, s28, 2
    s_add_u32 s48, s48, s3
    s_mul_i32 s48, s48, 6784
    s_add_u32 s48, s48, 344064
    s_sub_u32 s48, s48, s51
    s_mul_i32 s49, s29, 1792
    s_add_u32 s49, s49, 256
    v_lshlrev_b32 v3, 7, v1
    v_add_u32 v4, 256, v3
    v_cmp_gt_u32 vcc, 5, v1
    s_nop 1
    v_cndmask_b32 v4, v4, v3, vcc
    s_mov_b64 exec, 1023
    buffer_load_dword v137, v4, s[36:39], s49 offen
    s_mov_b32 exec_lo, -1
    s_mov_b32 exec_hi, 0x1fffff
    buffer_load_dword v138, v3, s[40:43], s48 offen
    s_mov_b64 exec, -1
    s_mov_b32 s32, s24
    s_mov_b32 s33, s25
    s_mov_b32 s34, 16777216
    s_mov_b32 s35, 0x20000
    v_cmp_gt_u32 vcc, 84, v0
    s_and_saveexec_b64 s[56:57], vcc
    v_mul_u32_u24 v8, 171, v0
    v_lshrrev_b32 v8, 9, v8
    v_mul_u32_u24 v8, 3, v8
    v_cmp_eq_u32 vcc, v8, v0
    v_mov_b32 v9, 0x3f80
    s_nop 0
    v_cndmask_b32 v8, 0, v9, vcc
    v_mov_b32 v9, 0
    v_mul_u32_u24 v7, 1088, v0
    v_add_u32 v7, 66616, v7
    ds_write_b64 v7, v[8:9]
    s_mov_b64 exec, s[56:57]
    v_and_b32 v7, 31, v1
    v_lshrrev_b32 v3, 5, v1
    v_lshrrev_b32 v4, 1, v7
    v_and_b32 v4, 7, v4
    v_xor_b32 v4, v4, v3
    s_lshl_b32 s48, s3, 1
    v_xor_b32 v4, s48, v4
    v_lshlrev_b32 v5, 7, v7
    v_add_u32 v5, s97, v5
    v_xor_b32 v6, 0, v4
    v_lshl_add_u32 v16, v6, 4, v5
    v_xor_b32 v6, 2, v4
    v_lshl_add_u32 v17, v6, 4, v5
    v_xor_b32 v6, 4, v4
    v_lshl_add_u32 v18, v6, 4, v5
    v_xor_b32 v6, 6, v4
    v_lshl_add_u32 v19, v6, 4, v5
    v_bfe_u32 v4, v1, 2, 2
    v_lshl_add_u32 v4, v3, 3, v4
    v_lshlrev_b32 v4, 6, v4
    v_bfe_u32 v5, v1, 4, 1
    v_lshl_add_u32 v4, v5, 5, v4
    v_and_b32 v6, 3, v1
    v_lshl_add_u32 v4, v6, 3, v4
    v_add_u32 v7, 256, v4
    v_and_b32 v6, 19, v1
    v_cmp_eq_u32 vcc, 19, v6
    v_mov_b32 v6, 1080
    s_nop 0
    v_cndmask_b32 v4, v4, v6, vcc
    v_cndmask_b32 v7, v7, v6, vcc
    s_xor_b32 s48, s3, 0
    s_mul_i32 s48, s48, 3264
    s_add_u32 s48, s48, 65536
    v_add_u32 v20, s48, v4
    v_add_u32 v21, s48, v7
    s_xor_b32 s48, s3, 1
    s_mul_i32 s48, s48, 3264
    s_add_u32 s48, s48, 65536
    v_add_u32 v22, s48, v4
    v_add_u32 v23, s48, v7
    s_xor_b32 s48, s3, 2
    s_mul_i32 s48, s48, 3264
    s_add_u32 s48, s48, 65536
    v_add_u32 v24, s48, v4
    v_add_u32 v25, s48, v7
    s_xor_b32 s48, s3, 3
    s_mul_i32 s48, s48, 3264
    s_add_u32 s48, s48, 65536
    v_add_u32 v26, s48, v4
    v_add_u32 v27, s48, v7
    v_mov_b32 v132, 0x3f803f80
    v_mov_b32 v133, 0x3f803f80
    s_and_b32 s50, s27, 1
    s_lshr_b32 s23, s27, 1
    s_mul_i32 s51, s28, 86
    s_lshr_b32 s51, s51, 8
    s_lshr_b32 s52, s28, 2
    s_cmp_eq_u32 s50, 0
    s_cselect_b32 s60, s52, s51
    s_sub_u32 s51, 4, s50
    s_mul_i32 s51, s51, s60
    s_sub_u32 s22, s28, s51
    s_lshl_b32 s51, s50, 2
    s_add_u32 s22, s22, s51
    s_mul_i32 s96, s3, 12288
    s_add_u32 s96, s96, 114688
    s_and_b32 s55, s3, 1
    s_waitcnt lgkmcnt(0)
    s_mov_b32 s10, s60
    s_mul_i32 s62, s28, 147
    s_lshr_b32 s62, s62, 10
    s_mul_i32 s60, s62, 7
    s_sub_u32 s60, s28, s60
    s_lshl_b32 s61, s27, 2
    s_add_u32 s61, s61, s62
    s_lshr_b32 s51, s26, 16
    s_add_u32 s51, s51, 0x1357
    s_and_b32 s51, s51, 0x3fff
    s_add_u32 s26, s26, 0x79b9
    s_and_b32 s26, s26, 0xffff
    s_lshl_b32 s51, s51, 16
    s_or_b32 s26, s26, s51
    s_getreg_b32 s11, hwreg(HW_REG_XCC_ID, 0, 4)
    s_lshl_b32 s11, s11, 28
    s_xor_b32 s11, s11, s26
    s_lshl_b32 s63, s27, 7
    s_add_u32 s63, s63, 1572992
    s_lshl_b32 s51, s28, 2
    s_add_u32 s51, s51, s63
    v_mov_b32 v3, s11
    s_cmp_eq_u32 s3, 0
    s_cselect_b32 s52, 0, 0x7fffffff
    v_mov_b32 v4, s52
    s_mov_b64 exec, 1
    buffer_store_dword v3, v4, s[32:35], s51 offen sc1
    s_mov_b64 exec, -1
    v_lshrrev_b32 v3, 3, v1
    v_mul_u32_u24 v3, 3584, v3
    v_and_b32 v4, 7, v1
    v_bfe_u32 v5, v1, 4, 1
    v_lshlrev_b32 v5, 2, v5
    v_xor_b32 v4, v4, v5
    v_lshl_add_u32 v244, v4, 4, v3
    v_add_u32 v245, 27648, v244
    v_lshrrev_b32 v3, 5, v1
    v_bfe_u32 v4, v1, 2, 2
    v_lshl_add_u32 v4, v3, 3, v4
    v_lshlrev_b32 v4, 7, v4
    v_bfe_u32 v5, v1, 4, 1
    v_lshl_add_u32 v4, v5, 5, v4
    v_and_b32 v5, 3, v1
    v_lshl_add_u32 v4, v5, 3, v4
    v_add_u32 v4, s96, v4
    v_bfe_u32 v5, v1, 3, 1
    v_xor_b32 v5, s55, v5
    v_lshl_add_u32 v240, v5, 6, v4
    v_xor_b32 v5, 1, v5
    v_lshl_add_u32 v241, v5, 6, v4
    v_lshrrev_b32 v3, 5, v1
    v_bfe_u32 v4, v1, 2, 2
    v_lshl_add_u32 v4, v3, 3, v4
    v_lshlrev_b32 v4, 7, v4
    v_bfe_u32 v5, v1, 4, 1
    v_lshl_add_u32 v4, v5, 5, v4
    v_and_b32 v5, 3, v1
    v_lshl_add_u32 v4, v5, 3, v4
    v_add_u32 v4, s97, v4
    v_bfe_u32 v5, v1, 3, 1
    v_xor_b32 v5, s55, v5
    v_lshl_add_u32 v242, v5, 6, v4
    v_xor_b32 v5, 1, v5
    v_lshl_add_u32 v243, v5, 6, v4
    s_mul_i32 s50, s23, 7
    s_add_u32 s50, s50, s10
    s_lshl_b32 s51, s50, 1
    s_add_u32 s51, s51, s55
    s_lshl_b32 s51, s51, 6
    v_lshrrev_b32 v3, 5, v1
    v_lshlrev_b32 v3, 3, v3
    s_mov_b32 s44, s14
    s_mov_b32 s45, s15
    s_mov_b32 s46, 3584
    s_mov_b32 s47, 0x20000
    buffer_load_dwordx2 v[246:247], v3, s[44:47], s51 offen offset:0
    buffer_load_dwordx2 v[248:249], v3, s[44:47], s51 offen offset:16
    buffer_load_dwordx2 v[250:251], v3, s[44:47], s51 offen offset:32
    buffer_load_dwordx2 v[252:253], v3, s[44:47], s51 offen offset:48
    s_lshl_b32 s51, s23, 3
    s_add_u32 s51, s51, s10
    s_lshl_b32 s51, s51, 1
    s_add_u32 s51, s51, s55
    s_lshl_b32 s51, s51, 6
    v_and_b32 v3, 31, v1
    v_lshlrev_b32 v3, 1, v3
    s_mov_b32 s44, s18
    s_mov_b32 s45, s19
    s_mov_b32 s46, 4096
    s_mov_b32 s47, 0x20000
    buffer_load_ushort v254, v3, s[44:47], s51 offen
    s_add_u32 m0, s97, 4096
    s_movk_i32 s48, 128
    buffer_load_dwordx4 v10, s[36:39], s48 offen offset:0 lds
    buffer_load_dwordx4 v11, s[36:39], s48 offen offset:1024 lds
    buffer_load_dwordx4 v12, s[36:39], s48 offen offset:2048 lds
    buffer_load_dwordx4 v13, s[36:39], s48 offen offset:3072 lds
    s_add_u32 m0, s53, 78592
    s_add_u32 s49, s54, 172032
    buffer_load_dwordx4 v14, s[40:43], s49 offen lds
    s_add_u32 m0, s53, 79680
    s_add_u32 s49, s54, 172928
    buffer_load_dwordx4 v14, s[40:43], s49 offen lds
    s_add_u32 m0, s53, 80768
    s_add_u32 s49, s54, 173824
    buffer_load_dwordx4 v14, s[40:43], s49 offen lds
    s_waitcnt vmcnt(15)
    s_waitcnt lgkmcnt(0)
    s_barrier
    ds_read_b128 v[32:35], v16 offset:0
    ds_read_b64_tr_b16 v[36:37], v20 offset:0
    ds_read_b64_tr_b16 v[38:39], v21 offset:0
    ds_read_b64_tr_b16 v[40:41], v20 offset:1088
    ds_read_b64_tr_b16 v[42:43], v21 offset:1088
    ds_read_b64_tr_b16 v[44:45], v20 offset:2176
    ds_read_b64_tr_b16 v[46:47], v21 offset:2176
    s_waitcnt lgkmcnt(4)
    v_mfma_f32_32x32x16_bf16 v[64:79], v[36:39], v[32:35], 0
    ds_read_b128 v[48:51], v17 offset:0
    ds_read_b64_tr_b16 v[52:53], v22 offset:0
    ds_read_b64_tr_b16 v[54:55], v23 offset:0
    s_add_u32 m0, s97, 8192
    s_movk_i32 s48, 256
    buffer_load_dwordx4 v10, s[36:39], s48 offen offset:0 lds
    v_mfma_f32_4x4x4_16b_bf16 v[112:115], v[32:33], v[32:33], 0
    s_waitcnt lgkmcnt(5)
    v_mfma_f32_32x32x16_bf16 v[80:95], v[40:43], v[32:35], 0
    ds_read_b64_tr_b16 v[56:57], v22 offset:1088
    ds_read_b64_tr_b16 v[58:59], v23 offset:1088
    buffer_load_dwordx4 v11, s[36:39], s48 offen offset:1024 lds
    v_mfma_f32_4x4x4_16b_bf16 v[116:119], v[34:35], v[34:35], 0
    s_waitcnt lgkmcnt(5)
    v_mfma_f32_32x32x16_bf16 v[96:111], v[32:35], v[44:47], 0
    ds_read_b64_tr_b16 v[60:61], v22 offset:2176
    ds_read_b64_tr_b16 v[62:63], v23 offset:2176
    v_mfma_f32_4x4x4_16b_bf16 v[120:123], v[132:133], v[36:37], 0
    v_mfma_f32_4x4x4_16b_bf16 v[124:127], v[132:133], v[40:41], 0
    v_mfma_f32_4x4x4_16b_bf16 v[128:131], v[132:133], v[44:45], 0
    v_mfma_f32_4x4x4_16b_bf16 v[120:123], v[132:133], v[38:39], v[120:123]
    v_mfma_f32_4x4x4_16b_bf16 v[124:127], v[132:133], v[42:43], v[124:127]
    v_mfma_f32_4x4x4_16b_bf16 v[128:131], v[132:133], v[46:47], v[128:131]
    s_waitcnt lgkmcnt(4)
    v_mfma_f32_32x32x16_bf16 v[64:79], v[52:55], v[48:51], v[64:79]
    ds_read_b128 v[32:35], v18 offset:0
    ds_read_b64_tr_b16 v[36:37], v24 offset:0
    ds_read_b64_tr_b16 v[38:39], v25 offset:0
    buffer_load_dwordx4 v12, s[36:39], s48 offen offset:2048 lds
    v_mfma_f32_4x4x4_16b_bf16 v[112:115], v[48:49], v[48:49], v[112:115]
    s_waitcnt lgkmcnt(5)
    v_mfma_f32_32x32x16_bf16 v[80:95], v[56:59], v[48:51], v[80:95]
    ds_read_b64_tr_b16 v[40:41], v24 offset:1088
    ds_read_b64_tr_b16 v[42:43], v25 offset:1088
    buffer_load_dwordx4 v13, s[36:39], s48 offen offset:3072 lds
    v_mfma_f32_4x4x4_16b_bf16 v[116:119], v[50:51], v[50:51], v[116:119]
    s_waitcnt lgkmcnt(5)
    v_mfma_f32_32x32x16_bf16 v[96:111], v[48:51], v[60:63], v[96:111]
    ds_read_b64_tr_b16 v[44:45], v24 offset:2176
    ds_read_b64_tr_b16 v[46:47], v25 offset:2176
    s_waitcnt lgkmcnt(4)
    v_mfma_f32_32x32x16_bf16 v[64:79], v[36:39], v[32:35], v[64:79]
    ds_read_b128 v[48:51], v19 offset:0
    ds_read_b64_tr_b16 v[52:53], v26 offset:0
    ds_read_b64_tr_b16 v[54:55], v27 offset:0
    s_add_u32 m0, s53, 91648
    s_add_u32 s49, s54, 344064
    buffer_load_dwordx4 v14, s[40:43], s49 offen lds
    v_mfma_f32_4x4x4_16b_bf16 v[112:115], v[32:33], v[32:33], v[112:115]
    s_waitcnt lgkmcnt(5)
    v_mfma_f32_32x32x16_bf16 v[80:95], v[40:43], v[32:35], v[80:95]
    ds_read_b64_tr_b16 v[56:57], v26 offset:1088
    ds_read_b64_tr_b16 v[58:59], v27 offset:1088
    s_add_u32 m0, s53, 92736
    s_add_u32 s49, s54, 344960
    buffer_load_dwordx4 v14, s[40:43], s49 offen lds
    v_mfma_f32_4x4x4_16b_bf16 v[116:119], v[34:35], v[34:35], v[116:119]
    s_waitcnt lgkmcnt(5)
    v_mfma_f32_32x32x16_bf16 v[96:111], v[32:35], v[44:47], v[96:111]
    ds_read_b64_tr_b16 v[60:61], v26 offset:2176
    ds_read_b64_tr_b16 v[62:63], v27 offset:2176
    s_waitcnt lgkmcnt(4)
    v_mfma_f32_32x32x16_bf16 v[64:79], v[52:55], v[48:51], v[64:79]
    s_waitcnt vmcnt(6)
    s_barrier
    ds_read_b128 v[32:35], v16 offset:4096
    ds_read_b64_tr_b16 v[36:37], v20 offset:13056
    ds_read_b64_tr_b16 v[38:39], v21 offset:13056
    s_add_u32 m0, s53, 93824
    s_add_u32 s49, s54, 345856
    buffer_load_dwordx4 v14, s[40:43], s49 offen lds
    v_mfma_f32_4x4x4_16b_bf16 v[112:115], v[48:49], v[48:49], v[112:115]
    s_waitcnt lgkmcnt(5)
    v_mfma_f32_32x32x16_bf16 v[80:95], v[56:59], v[48:51], v[80:95]
    ds_read_b64_tr_b16 v[40:41], v20 offset:14144
    ds_read_b64_tr_b16 v[42:43], v21 offset:14144
    v_mfma_f32_4x4x4_16b_bf16 v[116:119], v[50:51], v[50:51], v[116:119]
    s_waitcnt lgkmcnt(5)
    v_mfma_f32_32x32x16_bf16 v[96:111], v[48:51], v[60:63], v[96:111]
    ds_read_b64_tr_b16 v[44:45], v20 offset:15232
    ds_read_b64_tr_b16 v[46:47], v21 offset:15232
    s_waitcnt lgkmcnt(4)
    v_mfma_f32_32x32x16_bf16 v[64:79], v[36:39], v[32:35], v[64:79]
    ds_read_b128 v[48:51], v17 offset:4096
    ds_read_b64_tr_b16 v[52:53], v22 offset:13056
    ds_read_b64_tr_b16 v[54:55], v23 offset:13056
    s_add_u32 m0, s97, 12288
    s_movk_i32 s48, 384
    buffer_load_dwordx4 v10, s[36:39], s48 offen offset:0 lds
    v_mfma_f32_4x4x4_16b_bf16 v[112:115], v[32:33], v[32:33], v[112:115]
    s_waitcnt lgkmcnt(5)
    v_mfma_f32_32x32x16_bf16 v[80:95], v[40:43], v[32:35], v[80:95]
    ds_read_b64_tr_b16 v[56:57], v22 offset:14144
    ds_read_b64_tr_b16 v[58:59], v23 offset:14144
    buffer_load_dwordx4 v11, s[36:39], s48 offen offset:1024 lds
    v_mfma_f32_4x4x4_16b_bf16 v[116:119], v[34:35], v[34:35], v[116:119]
    s_waitcnt lgkmcnt(5)
    v_mfma_f32_32x32x16_bf16 v[96:111], v[32:35], v[44:47], v[96:111]
    ds_read_b64_tr_b16 v[60:61], v22 offset:15232
    ds_read_b64_tr_b16 v[62:63], v23 offset:15232
    v_mfma_f32_4x4x4_16b_bf16 v[120:123], v[132:133], v[36:37], v[120:123]
    v_mfma_f32_4x4x4_16b_bf16 v[124:127], v[132:133], v[40:41], v[124:127]
    v_mfma_f32_4x4x4_16b_bf16 v[128:131], v[132:133], v[44:45], v[128:131]
    v_mfma_f32_4x4x4_16b_bf16 v[120:123], v[132:133], v[38:39], v[120:123]
    v_mfma_f32_4x4x4_16b_bf16 v[124:127], v[132:133], v[42:43], v[124:127]
    v_mfma_f32_4x4x4_16b_bf16 v[128:131], v[132:133], v[46:47], v[128:131]
    s_waitcnt lgkmcnt(4)
    v_mfma_f32_32x32x16_bf16 v[64:79], v[52:55], v[48:51], v[64:79]
    ds_read_b128 v[32:35], v18 offset:4096
    ds_read_b64_tr_b16 v[36:37], v24 offset:13056
    ds_read_b64_tr_b16 v[38:39], v25 offset:13056
    buffer_load_dwordx4 v12, s[36:39], s48 offen offset:2048 lds
    v_mfma_f32_4x4x4_16b_bf16 v[112:115], v[48:49], v[48:49], v[112:115]
    s_waitcnt lgkmcnt(5)
    v_mfma_f32_32x32x16_bf16 v[80:95], v[56:59], v[48:51], v[80:95]
    ds_read_b64_tr_b16 v[40:41], v24 offset:14144
    ds_read_b64_tr_b16 v[42:43], v25 offset:14144
    buffer_load_dwordx4 v13, s[36:39], s48 offen offset:3072 lds
    v_mfma_f32_4x4x4_16b_bf16 v[116:119], v[50:51], v[50:51], v[116:119]
    s_waitcnt lgkmcnt(5)
    v_mfma_f32_32x32x16_bf16 v[96:111], v[48:51], v[60:63], v[96:111]
    ds_read_b64_tr_b16 v[44:45], v24 offset:15232
    ds_read_b64_tr_b16 v[46:47], v25 offset:15232
    s_waitcnt lgkmcnt(4)
    v_mfma_f32_32x32x16_bf16 v[64:79], v[36:39], v[32:35], v[64:79]
    ds_read_b128 v[48:51], v19 offset:4096
    ds_read_b64_tr_b16 v[52:53], v26 offset:13056
    ds_read_b64_tr_b16 v[54:55], v27 offset:13056
    s_add_u32 m0, s53, 104704
    s_add_u32 s49, s54, 516096
    buffer_load_dwordx4 v14, s[40:43], s49 offen lds
    v_mfma_f32_4x4x4_16b_bf16 v[112:115], v[32:33], v[32:33], v[112:115]
    s_waitcnt lgkmcnt(5)
    v_mfma_f32_32x32x16_bf16 v[80:95], v[40:43], v[32:35], v[80:95]
    ds_read_b64_tr_b16 v[56:57], v26 offset:14144
    ds_read_b64_tr_b16 v[58:59], v27 offset:14144
    s_add_u32 m0, s53, 105792
    s_add_u32 s49, s54, 516992
    buffer_load_dwordx4 v14, s[40:43], s49 offen lds
    v_mfma_f32_4x4x4_16b_bf16 v[116:119], v[34:35], v[34:35], v[116:119]
    s_waitcnt lgkmcnt(5)
    v_mfma_f32_32x32x16_bf16 v[96:111], v[32:35], v[44:47], v[96:111]
    ds_read_b64_tr_b16 v[60:61], v26 offset:15232
    ds_read_b64_tr_b16 v[62:63], v27 offset:15232
    s_waitcnt lgkmcnt(4)
    v_mfma_f32_32x32x16_bf16 v[64:79], v[52:55], v[48:51], v[64:79]
    s_waitcnt vmcnt(6)
    s_barrier
    ds_read_b128 v[32:35], v16 offset:8192
    ds_read_b64_tr_b16 v[36:37], v20 offset:26112
    ds_read_b64_tr_b16 v[38:39], v21 offset:26112
    s_add_u32 m0, s53, 106880
    s_add_u32 s49, s54, 517888
    buffer_load_dwordx4 v14, s[40:43], s49 offen lds
    v_mfma_f32_4x4x4_16b_bf16 v[112:115], v[48:49], v[48:49], v[112:115]
    s_waitcnt lgkmcnt(5)
    v_mfma_f32_32x32x16_bf16 v[80:95], v[56:59], v[48:51], v[80:95]
    ds_read_b64_tr_b16 v[40:41], v20 offset:27200
    ds_read_b64_tr_b16 v[42:43], v21 offset:27200
    v_mfma_f32_4x4x4_16b_bf16 v[116:119], v[50:51], v[50:51], v[116:119]
    s_waitcnt lgkmcnt(5)
    v_mfma_f32_32x32x16_bf16 v[96:111], v[48:51], v[60:63], v[96:111]
    ds_read_b64_tr_b16 v[44:45], v20 offset:28288
    ds_read_b64_tr_b16 v[46:47], v21 offset:28288
    s_waitcnt lgkmcnt(4)
    v_mfma_f32_32x32x16_bf16 v[64:79], v[36:39], v[32:35], v[64:79]
    ds_read_b128 v[48:51], v17 offset:8192
    ds_read_b64_tr_b16 v[52:53], v22 offset:26112
    ds_read_b64_tr_b16 v[54:55], v23 offset:26112
    s_add_u32 m0, s97, 0
    s_movk_i32 s48, 512
    buffer_load_dwordx4 v10, s[36:39], s48 offen offset:0 lds
    v_mfma_f32_4x4x4_16b_bf16 v[112:115], v[32:33], v[32:33], v[112:115]
    s_waitcnt lgkmcnt(5)
    v_mfma_f32_32x32x16_bf16 v[80:95], v[40:43], v[32:35], v[80:95]
    ds_read_b64_tr_b16 v[56:57], v22 offset:27200
    ds_read_b64_tr_b16 v[58:59], v23 offset:27200
    buffer_load_dwordx4 v11, s[36:39], s48 offen offset:1024 lds
    v_mfma_f32_4x4x4_16b_bf16 v[116:119], v[34:35], v[34:35], v[116:119]
    s_waitcnt lgkmcnt(5)
    v_mfma_f32_32x32x16_bf16 v[96:111], v[32:35], v[44:47], v[96:111]
    ds_read_b64_tr_b16 v[60:61], v22 offset:28288
    ds_read_b64_tr_b16 v[62:63], v23 offset:28288
    v_mfma_f32_4x4x4_16b_bf16 v[120:123], v[132:133], v[36:37], v[120:123]
    v_mfma_f32_4x4x4_16b_bf16 v[124:127], v[132:133], v[40:41], v[124:127]
    v_mfma_f32_4x4x4_16b_bf16 v[128:131], v[132:133], v[44:45], v[128:131]
    v_mfma_f32_4x4x4_16b_bf16 v[120:123], v[132:133], v[38:39], v[120:123]
    v_mfma_f32_4x4x4_16b_bf16 v[124:127], v[132:133], v[42:43], v[124:127]
    v_mfma_f32_4x4x4_16b_bf16 v[128:131], v[132:133], v[46:47], v[128:131]
    s_waitcnt lgkmcnt(4)
    v_mfma_f32_32x32x16_bf16 v[64:79], v[52:55], v[48:51], v[64:79]
    ds_read_b128 v[32:35], v18 offset:8192
    ds_read_b64_tr_b16 v[36:37], v24 offset:26112
    ds_read_b64_tr_b16 v[38:39], v25 offset:26112
    buffer_load_dwordx4 v12, s[36:39], s48 offen offset:2048 lds
    v_mfma_f32_4x4x4_16b_bf16 v[112:115], v[48:49], v[48:49], v[112:115]
    s_waitcnt lgkmcnt(5)
    v_mfma_f32_32x32x16_bf16 v[80:95], v[56:59], v[48:51], v[80:95]
    ds_read_b64_tr_b16 v[40:41], v24 offset:27200
    ds_read_b64_tr_b16 v[42:43], v25 offset:27200
    buffer_load_dwordx4 v13, s[36:39], s48 offen offset:3072 lds
    v_mfma_f32_4x4x4_16b_bf16 v[116:119], v[50:51], v[50:51], v[116:119]
    s_waitcnt lgkmcnt(5)
    v_mfma_f32_32x32x16_bf16 v[96:111], v[48:51], v[60:63], v[96:111]
    ds_read_b64_tr_b16 v[44:45], v24 offset:28288
    ds_read_b64_tr_b16 v[46:47], v25 offset:28288
    s_waitcnt lgkmcnt(4)
    v_mfma_f32_32x32x16_bf16 v[64:79], v[36:39], v[32:35], v[64:79]
    ds_read_b128 v[48:51], v19 offset:8192
    ds_read_b64_tr_b16 v[52:53], v26 offset:26112
    ds_read_b64_tr_b16 v[54:55], v27 offset:26112
    s_add_u32 m0, s53, 117760
    s_add_u32 s49, s54, 688128
    buffer_load_dwordx4 v14, s[40:43], s49 offen lds
    v_mfma_f32_4x4x4_16b_bf16 v[112:115], v[32:33], v[32:33], v[112:115]
    s_waitcnt lgkmcnt(5)
    v_mfma_f32_32x32x16_bf16 v[80:95], v[40:43], v[32:35], v[80:95]
    ds_read_b64_tr_b16 v[56:57], v26 offset:27200
    ds_read_b64_tr_b16 v[58:59], v27 offset:27200
    s_add_u32 m0, s53, 118848
    s_add_u32 s49, s54, 689024
    buffer_load_dwordx4 v14, s[40:43], s49 offen lds
    v_mfma_f32_4x4x4_16b_bf16 v[116:119], v[34:35], v[34:35], v[116:119]
    s_waitcnt lgkmcnt(5)
    v_mfma_f32_32x32x16_bf16 v[96:111], v[32:35], v[44:47], v[96:111]
    ds_read_b64_tr_b16 v[60:61], v26 offset:28288
    ds_read_b64_tr_b16 v[62:63], v27 offset:28288
    s_waitcnt lgkmcnt(4)
    v_mfma_f32_32x32x16_bf16 v[64:79], v[52:55], v[48:51], v[64:79]
    s_waitcnt vmcnt(6)
    s_barrier
    ds_read_b128 v[32:35], v16 offset:12288
    ds_read_b64_tr_b16 v[36:37], v20 offset:39168
    ds_read_b64_tr_b16 v[38:39], v21 offset:39168
    s_add_u32 m0, s53, 119936
    s_add_u32 s49, s54, 689920
    buffer_load_dwordx4 v14, s[40:43], s49 offen lds
    v_mfma_f32_4x4x4_16b_bf16 v[112:115], v[48:49], v[48:49], v[112:115]
    s_waitcnt lgkmcnt(5)
    v_mfma_f32_32x32x16_bf16 v[80:95], v[56:59], v[48:51], v[80:95]
    ds_read_b64_tr_b16 v[40:41], v20 offset:40256
    ds_read_b64_tr_b16 v[42:43], v21 offset:40256
    v_mfma_f32_4x4x4_16b_bf16 v[116:119], v[50:51], v[50:51], v[116:119]
    s_waitcnt lgkmcnt(5)
    v_mfma_f32_32x32x16_bf16 v[96:111], v[48:51], v[60:63], v[96:111]
    ds_read_b64_tr_b16 v[44:45], v20 offset:41344
    ds_read_b64_tr_b16 v[46:47], v21 offset:41344
    s_waitcnt lgkmcnt(4)
    v_mfma_f32_32x32x16_bf16 v[64:79], v[36:39], v[32:35], v[64:79]
    ds_read_b128 v[48:51], v17 offset:12288
    ds_read_b64_tr_b16 v[52:53], v22 offset:39168
    ds_read_b64_tr_b16 v[54:55], v23 offset:39168
    s_add_u32 m0, s97, 4096
    s_movk_i32 s48, 640
    buffer_load_dwordx4 v10, s[36:39], s48 offen offset:0 lds
    v_mfma_f32_4x4x4_16b_bf16 v[112:115], v[32:33], v[32:33], v[112:115]
    s_waitcnt lgkmcnt(5)
    v_mfma_f32_32x32x16_bf16 v[80:95], v[40:43], v[32:35], v[80:95]
    ds_read_b64_tr_b16 v[56:57], v22 offset:40256
    ds_read_b64_tr_b16 v[58:59], v23 offset:40256
    buffer_load_dwordx4 v11, s[36:39], s48 offen offset:1024 lds
    v_mfma_f32_4x4x4_16b_bf16 v[116:119], v[34:35], v[34:35], v[116:119]
    s_waitcnt lgkmcnt(5)
    v_mfma_f32_32x32x16_bf16 v[96:111], v[32:35], v[44:47], v[96:111]
    ds_read_b64_tr_b16 v[60:61], v22 offset:41344
    ds_read_b64_tr_b16 v[62:63], v23 offset:41344
    v_mfma_f32_4x4x4_16b_bf16 v[120:123], v[132:133], v[36:37], v[120:123]
    v_mfma_f32_4x4x4_16b_bf16 v[124:127], v[132:133], v[40:41], v[124:127]
    v_mfma_f32_4x4x4_16b_bf16 v[128:131], v[132:133], v[44:45], v[128:131]
    v_mfma_f32_4x4x4_16b_bf16 v[120:123], v[132:133], v[38:39], v[120:123]
    v_mfma_f32_4x4x4_16b_bf16 v[124:127], v[132:133], v[42:43], v[124:127]
    v_mfma_f32_4x4x4_16b_bf16 v[128:131], v[132:133], v[46:47], v[128:131]
    s_waitcnt lgkmcnt(4)
    v_mfma_f32_32x32x16_bf16 v[64:79], v[52:55], v[48:51], v[64:79]
    ds_read_b128 v[32:35], v18 offset:12288
    ds_read_b64_tr_b16 v[36:37], v24 offset:39168
    ds_read_b64_tr_b16 v[38:39], v25 offset:39168
    buffer_load_dwordx4 v12, s[36:39], s48 offen offset:2048 lds
    v_mfma_f32_4x4x4_16b_bf16 v[112:115], v[48:49], v[48:49], v[112:115]
    s_waitcnt lgkmcnt(5)
    v_mfma_f32_32x32x16_bf16 v[80:95], v[56:59], v[48:51], v[80:95]
    ds_read_b64_tr_b16 v[40:41], v24 offset:40256
    ds_read_b64_tr_b16 v[42:43], v25 offset:40256
    buffer_load_dwordx4 v13, s[36:39], s48 offen offset:3072 lds
    v_mfma_f32_4x4x4_16b_bf16 v[116:119], v[50:51], v[50:51], v[116:119]
    s_waitcnt lgkmcnt(5)
    v_mfma_f32_32x32x16_bf16 v[96:111], v[48:51], v[60:63], v[96:111]
    ds_read_b64_tr_b16 v[44:45], v24 offset:41344
    ds_read_b64_tr_b16 v[46:47], v25 offset:41344
    s_waitcnt lgkmcnt(4)
    v_mfma_f32_32x32x16_bf16 v[64:79], v[36:39], v[32:35], v[64:79]
    ds_read_b128 v[48:51], v19 offset:12288
    ds_read_b64_tr_b16 v[52:53], v26 offset:39168
    ds_read_b64_tr_b16 v[54:55], v27 offset:39168
    s_add_u32 m0, s53, 130816
    s_add_u32 s49, s54, 860160
    buffer_load_dwordx4 v14, s[40:43], s49 offen lds
    v_mfma_f32_4x4x4_16b_bf16 v[112:115], v[32:33], v[32:33], v[112:115]
    s_waitcnt lgkmcnt(5)
    v_mfma_f32_32x32x16_bf16 v[80:95], v[40:43], v[32:35], v[80:95]
    ds_read_b64_tr_b16 v[56:57], v26 offset:40256
    ds_read_b64_tr_b16 v[58:59], v27 offset:40256
    s_add_u32 m0, s53, 131904
    s_add_u32 s49, s54, 861056
    buffer_load_dwordx4 v14, s[40:43], s49 offen lds
    v_mfma_f32_4x4x4_16b_bf16 v[116:119], v[34:35], v[34:35], v[116:119]
    s_waitcnt lgkmcnt(5)
    v_mfma_f32_32x32x16_bf16 v[96:111], v[32:35], v[44:47], v[96:111]
    ds_read_b64_tr_b16 v[60:61], v26 offset:41344
    ds_read_b64_tr_b16 v[62:63], v27 offset:41344
    s_waitcnt lgkmcnt(4)
    v_mfma_f32_32x32x16_bf16 v[64:79], v[52:55], v[48:51], v[64:79]
    s_waitcnt vmcnt(6)
    s_barrier
    v_add_u32 v20, 52224, v20
    v_add_u32 v21, 52224, v21
    v_add_u32 v22, 52224, v22
    v_add_u32 v23, 52224, v23
    v_add_u32 v24, 52224, v24
    v_add_u32 v25, 52224, v25
    v_add_u32 v26, 52224, v26
    v_add_u32 v27, 52224, v27
    ds_read_b128 v[32:35], v16 offset:0
    ds_read_b64_tr_b16 v[36:37], v20 offset:0
    ds_read_b64_tr_b16 v[38:39], v21 offset:0
    s_add_u32 m0, s53, 132992
    s_add_u32 s49, s54, 861952
    buffer_load_dwordx4 v14, s[40:43], s49 offen lds
    v_mfma_f32_4x4x4_16b_bf16 v[112:115], v[48:49], v[48:49], v[112:115]
    s_waitcnt lgkmcnt(5)
    v_mfma_f32_32x32x16_bf16 v[80:95], v[56:59], v[48:51], v[80:95]
    ds_read_b64_tr_b16 v[40:41], v20 offset:1088
    ds_read_b64_tr_b16 v[42:43], v21 offset:1088
    v_mfma_f32_4x4x4_16b_bf16 v[116:119], v[50:51], v[50:51], v[116:119]
    s_waitcnt lgkmcnt(5)
    v_mfma_f32_32x32x16_bf16 v[96:111], v[48:51], v[60:63], v[96:111]
    ds_read_b64_tr_b16 v[44:45], v20 offset:2176
    ds_read_b64_tr_b16 v[46:47], v21 offset:2176
    s_waitcnt lgkmcnt(4)
    v_mfma_f32_32x32x16_bf16 v[64:79], v[36:39], v[32:35], v[64:79]
    ds_read_b128 v[48:51], v17 offset:0
    ds_read_b64_tr_b16 v[52:53], v22 offset:0
    ds_read_b64_tr_b16 v[54:55], v23 offset:0
    s_add_u32 m0, s97, 8192
    s_movk_i32 s48, 768
    buffer_load_dwordx4 v10, s[36:39], s48 offen offset:0 lds
    v_mfma_f32_4x4x4_16b_bf16 v[112:115], v[32:33], v[32:33], v[112:115]
    s_waitcnt lgkmcnt(5)
    v_mfma_f32_32x32x16_bf16 v[80:95], v[40:43], v[32:35], v[80:95]
    ds_read_b64_tr_b16 v[56:57], v22 offset:1088
    ds_read_b64_tr_b16 v[58:59], v23 offset:1088
    buffer_load_dwordx4 v11, s[36:39], s48 offen offset:1024 lds
    v_mfma_f32_4x4x4_16b_bf16 v[116:119], v[34:35], v[34:35], v[116:119]
    s_waitcnt lgkmcnt(5)
    v_mfma_f32_32x32x16_bf16 v[96:111], v[32:35], v[44:47], v[96:111]
    ds_read_b64_tr_b16 v[60:61], v22 offset:2176
    ds_read_b64_tr_b16 v[62:63], v23 offset:2176
    v_mfma_f32_4x4x4_16b_bf16 v[120:123], v[132:133], v[36:37], v[120:123]
    v_mfma_f32_4x4x4_16b_bf16 v[124:127], v[132:133], v[40:41], v[124:127]
    v_mfma_f32_4x4x4_16b_bf16 v[128:131], v[132:133], v[44:45], v[128:131]
    v_mfma_f32_4x4x4_16b_bf16 v[120:123], v[132:133], v[38:39], v[120:123]
    v_mfma_f32_4x4x4_16b_bf16 v[124:127], v[132:133], v[42:43], v[124:127]
    v_mfma_f32_4x4x4_16b_bf16 v[128:131], v[132:133], v[46:47], v[128:131]
    s_waitcnt lgkmcnt(4)
    v_mfma_f32_32x32x16_bf16 v[64:79], v[52:55], v[48:51], v[64:79]
    ds_read_b128 v[32:35], v18 offset:0
    ds_read_b64_tr_b16 v[36:37], v24 offset:0
    ds_read_b64_tr_b16 v[38:39], v25 offset:0
    buffer_load_dwordx4 v12, s[36:39], s48 offen offset:2048 lds
    v_mfma_f32_4x4x4_16b_bf16 v[112:115], v[48:49], v[48:49], v[112:115]
    s_waitcnt lgkmcnt(5)
    v_mfma_f32_32x32x16_bf16 v[80:95], v[56:59], v[48:51], v[80:95]
    ds_read_b64_tr_b16 v[40:41], v24 offset:1088
    ds_read_b64_tr_b16 v[42:43], v25 offset:1088
    buffer_load_dwordx4 v13, s[36:39], s48 offen offset:3072 lds
    v_mfma_f32_4x4x4_16b_bf16 v[116:119], v[50:51], v[50:51], v[116:119]
    s_waitcnt lgkmcnt(5)
    v_mfma_f32_32x32x16_bf16 v[96:111], v[48:51], v[60:63], v[96:111]
    ds_read_b64_tr_b16 v[44:45], v24 offset:2176
    ds_read_b64_tr_b16 v[46:47], v25 offset:2176
    s_waitcnt lgkmcnt(4)
    v_mfma_f32_32x32x16_bf16 v[64:79], v[36:39], v[32:35], v[64:79]
    ds_read_b128 v[48:51], v19 offset:0
    ds_read_b64_tr_b16 v[52:53], v26 offset:0
    ds_read_b64_tr_b16 v[54:55], v27 offset:0
    s_add_u32 m0, s53, 143872
    s_add_u32 s49, s54, 1032192
    buffer_load_dwordx4 v14, s[40:43], s49 offen lds
    v_mfma_f32_4x4x4_16b_bf16 v[112:115], v[32:33], v[32:33], v[112:115]
    s_waitcnt lgkmcnt(5)
    v_mfma_f32_32x32x16_bf16 v[80:95], v[40:43], v[32:35], v[80:95]
    ds_read_b64_tr_b16 v[56:57], v26 offset:1088
    ds_read_b64_tr_b16 v[58:59], v27 offset:1088
    s_add_u32 m0, s53, 144960
    s_add_u32 s49, s54, 1033088
    buffer_load_dwordx4 v14, s[40:43], s49 offen lds
    v_mfma_f32_4x4x4_16b_bf16 v[116:119], v[34:35], v[34:35], v[116:119]
    s_waitcnt lgkmcnt(5)
    v_mfma_f32_32x32x16_bf16 v[96:111], v[32:35], v[44:47], v[96:111]
    ds_read_b64_tr_b16 v[60:61], v26 offset:2176
    ds_read_b64_tr_b16 v[62:63], v27 offset:2176
    s_waitcnt lgkmcnt(4)
    v_mfma_f32_32x32x16_bf16 v[64:79], v[52:55], v[48:51], v[64:79]
    s_waitcnt vmcnt(6)
    s_barrier
    ds_read_b128 v[32:35], v16 offset:4096
    ds_read_b64_tr_b16 v[36:37], v20 offset:13056
    ds_read_b64_tr_b16 v[38:39], v21 offset:13056
    s_add_u32 m0, s53, 146048
    s_add_u32 s49, s54, 1033984
    buffer_load_dwordx4 v14, s[40:43], s49 offen lds
    v_mfma_f32_4x4x4_16b_bf16 v[112:115], v[48:49], v[48:49], v[112:115]
    s_waitcnt lgkmcnt(5)
    v_mfma_f32_32x32x16_bf16 v[80:95], v[56:59], v[48:51], v[80:95]
    ds_read_b64_tr_b16 v[40:41], v20 offset:14144
    ds_read_b64_tr_b16 v[42:43], v21 offset:14144
    v_mfma_f32_4x4x4_16b_bf16 v[116:119], v[50:51], v[50:51], v[116:119]
    s_waitcnt lgkmcnt(5)
    v_mfma_f32_32x32x16_bf16 v[96:111], v[48:51], v[60:63], v[96:111]
    ds_read_b64_tr_b16 v[44:45], v20 offset:15232
    ds_read_b64_tr_b16 v[46:47], v21 offset:15232
    s_waitcnt lgkmcnt(4)
    v_mfma_f32_32x32x16_bf16 v[64:79], v[36:39], v[32:35], v[64:79]
    ds_read_b128 v[48:51], v17 offset:4096
    ds_read_b64_tr_b16 v[52:53], v22 offset:13056
    ds_read_b64_tr_b16 v[54:55], v23 offset:13056
    s_lshl_b32 s64, s29, 6
    s_add_u32 s64, s64, s31
    s_lshl_b32 s64, s64, 7
    s_add_u32 s64, s64, 1048576
    s_lshl_b32 s65, s31, 4
    s_add_u32 s65, s65, s29
    s_lshl_b32 s72, s65, 11
    s_add_u32 s72, s72, 6290432
    s_lshl_b32 s65, s65, 7
    s_add_u32 s65, s65, 1179648
    s_lshr_b32 s56, s3, 1
    s_lshl_b32 s68, s61, 1
    s_add_u32 s68, s68, s56
    s_lshl_b32 s66, s60, 6
    s_add_u32 s66, s66, s68
    s_lshl_b32 s66, s66, 1
    s_add_u32 s66, s66, s55
    s_lshl_b32 s66, s66, 7
    s_add_u32 s66, s66, 1310720
    s_mul_i32 s68, s68, 14
    s_lshl_b32 s69, s60, 1
    s_add_u32 s68, s68, s69
    s_add_u32 s68, s68, s55
    s_lshl_b32 s68, s68, 9
    s_add_u32 s68, s68, 14679552
    s_mul_i32 s67, s22, 56
    s_lshl_b32 s69, s50, 1
    s_add_u32 s67, s67, s69
    s_add_u32 s67, s67, s55
    s_lshl_b32 s67, s67, 1
    s_add_u32 s67, s67, s56
    s_lshl_b32 s67, s67, 7
    s_add_u32 s67, s67, 1441792
    v_lshlrev_b32 v4, 7, v1
    v_add_u32 v5, s72, v4
    v_add_u32 v4, s68, v4
    v_cmp_gt_u32 vcc, 8, v1
    s_nop 1
    v_cndmask_b32 v4, v5, v4, vcc
    v_writelane_b32 v4, s64, 0
    v_writelane_b32 v4, s65, 1
    v_writelane_b32 v4, s66, 2
    v_writelane_b32 v4, s67, 3
    s_mov_b64 exec, 16777215
    buffer_load_dword v136, v4, s[32:35], 0 offen
    s_mov_b64 exec, -1
    v_mfma_f32_4x4x4_16b_bf16 v[112:115], v[32:33], v[32:33], v[112:115]
    s_waitcnt lgkmcnt(5)
    v_mfma_f32_32x32x16_bf16 v[80:95], v[40:43], v[32:35], v[80:95]
    ds_read_b64_tr_b16 v[56:57], v22 offset:14144
    ds_read_b64_tr_b16 v[58:59], v23 offset:14144
    v_and_b32 v141, 31, v1
    v_lshlrev_b32 v141, 2, v141
    buffer_load_dword v140, v141, s[32:35], s63 offen sc1
    v_mfma_f32_4x4x4_16b_bf16 v[116:119], v[34:35], v[34:35], v[116:119]
    s_waitcnt lgkmcnt(5)
    v_mfma_f32_32x32x16_bf16 v[96:111], v[32:35], v[44:47], v[96:111]
    ds_read_b64_tr_b16 v[60:61], v22 offset:15232
    ds_read_b64_tr_b16 v[62:63], v23 offset:15232
    v_mfma_f32_4x4x4_16b_bf16 v[120:123], v[132:133], v[36:37], v[120:123]
    v_mfma_f32_4x4x4_16b_bf16 v[124:127], v[132:133], v[40:41], v[124:127]
    v_mfma_f32_4x4x4_16b_bf16 v[128:131], v[132:133], v[44:45], v[128:131]
    v_mfma_f32_4x4x4_16b_bf16 v[120:123], v[132:133], v[38:39], v[120:123]
    v_mfma_f32_4x4x4_16b_bf16 v[124:127], v[132:133], v[42:43], v[124:127]
    v_mfma_f32_4x4x4_16b_bf16 v[128:131], v[132:133], v[46:47], v[128:131]
    s_waitcnt lgkmcnt(4)
    v_mfma_f32_32x32x16_bf16 v[64:79], v[52:55], v[48:51], v[64:79]
    ds_read_b128 v[32:35], v18 offset:4096
    ds_read_b64_tr_b16 v[36:37], v24 offset:13056
    ds_read_b64_tr_b16 v[38:39], v25 offset:13056
    s_and_b32 s51, s27, 1
    s_lshl_b32 s51, s51, 5
    s_add_u32 s51, s51, s28
    s_lshl_b32 s51, s51, 2
    s_add_u32 s51, s51, s3
    s_lshr_b32 s52, s51, 6
    s_lshl_b32 s52, s52, 4
    s_bfe_u32 s56, s51, 0x20004
    s_lshl_b32 s56, s56, 9
    s_add_u32 s52, s52, s56
    s_and_b32 s51, s51, 15
    s_add_u32 s52, s52, s51
    s_mul_i32 s52, s52, 3584
    s_mul_i32 s51, s23, 896
    s_add_u32 s52, s52, s51
    s_mov_b32 s54, s52
    s_mov_b32 s44, s12
    s_mov_b32 s45, s13
    s_mov_b32 s46, 7340032
    s_mov_b32 s47, 0x20000
    v_mul_u32_u24 v4, 37, v1
    v_lshrrev_b32 v4, 8, v4
    v_mul_u32_u24 v4, 228480, v4
    v_lshl_add_u32 v4, v1, 7, v4
    s_mov_b32 exec_lo, 0x3fff
    s_mov_b32 exec_hi, 0x0
    buffer_load_dword v137, v4, s[44:47], s54 offen
    s_mov_b64 exec, -1
    v_mfma_f32_4x4x4_16b_bf16 v[112:115], v[48:49], v[48:49], v[112:115]
    s_waitcnt lgkmcnt(5)
    v_mfma_f32_32x32x16_bf16 v[80:95], v[56:59], v[48:51], v[80:95]
    ds_read_b64_tr_b16 v[40:41], v24 offset:14144
    ds_read_b64_tr_b16 v[42:43], v25 offset:14144
    s_mov_b32 s44, s8
    s_mov_b32 s45, s9
    s_mov_b32 s46, 401408
    s_mov_b32 s47, 0x20000
    s_lshl_b32 s51, s28, 2
    s_add_u32 s51, s51, s3
    s_mul_i32 s51, s51, 3200
    v_lshlrev_b32 v3, 7, v1
    s_mov_b64 exec, 0x1ffffff
    buffer_load_dword v139, v3, s[44:47], s51 offen
    s_mov_b64 exec, -1
    v_mfma_f32_4x4x4_16b_bf16 v[116:119], v[50:51], v[50:51], v[116:119]
    s_waitcnt lgkmcnt(5)
    v_mfma_f32_32x32x16_bf16 v[96:111], v[48:51], v[60:63], v[96:111]
    ds_read_b64_tr_b16 v[44:45], v24 offset:15232
    ds_read_b64_tr_b16 v[46:47], v25 offset:15232
    s_waitcnt lgkmcnt(4)
    v_mfma_f32_32x32x16_bf16 v[64:79], v[36:39], v[32:35], v[64:79]
    ds_read_b128 v[48:51], v19 offset:4096
    ds_read_b64_tr_b16 v[52:53], v26 offset:13056
    ds_read_b64_tr_b16 v[54:55], v27 offset:13056
    s_mul_i32 s51, s3, 1835008
    s_lshl_b32 s50, s50, 7
    s_add_u32 s51, s51, s50
    s_sub_u32 s52, 7340032, s51
    s_cmp_lt_u32 s10, 7
    s_cselect_b32 s52, s52, 0
    s_cselect_b32 s51, s51, 0
    s_add_u32 s44, s12, s51
    s_addc_u32 s45, s13, 0
    s_mov_b32 s46, s52
    s_mov_b32 s47, 0x20000
    v_mfma_f32_4x4x4_16b_bf16 v[112:115], v[32:33], v[32:33], v[112:115]
    s_waitcnt lgkmcnt(5)
    v_mfma_f32_32x32x16_bf16 v[80:95], v[40:43], v[32:35], v[80:95]
    ds_read_b64_tr_b16 v[56:57], v26 offset:14144
    ds_read_b64_tr_b16 v[58:59], v27 offset:14144
    v_mfma_f32_4x4x4_16b_bf16 v[116:119], v[34:35], v[34:35], v[116:119]
    s_waitcnt lgkmcnt(5)
    v_mfma_f32_32x32x16_bf16 v[96:111], v[32:35], v[44:47], v[96:111]
    ds_read_b64_tr_b16 v[60:61], v26 offset:15232
    ds_read_b64_tr_b16 v[62:63], v27 offset:15232
    s_waitcnt lgkmcnt(4)
    v_mfma_f32_32x32x16_bf16 v[64:79], v[52:55], v[48:51], v[64:79]
    s_waitcnt vmcnt(4)
    s_barrier
    ds_read_b128 v[32:35], v16 offset:8192
    ds_read_b64_tr_b16 v[36:37], v20 offset:26112
    ds_read_b64_tr_b16 v[38:39], v21 offset:26112
    v_mfma_f32_4x4x4_16b_bf16 v[112:115], v[48:49], v[48:49], v[112:115]
    s_waitcnt lgkmcnt(5)
    v_mfma_f32_32x32x16_bf16 v[80:95], v[56:59], v[48:51], v[80:95]
    ds_read_b64_tr_b16 v[40:41], v20 offset:27200
    ds_read_b64_tr_b16 v[42:43], v21 offset:27200
    v_mfma_f32_4x4x4_16b_bf16 v[116:119], v[50:51], v[50:51], v[116:119]
    s_waitcnt lgkmcnt(5)
    v_mfma_f32_32x32x16_bf16 v[96:111], v[48:51], v[60:63], v[96:111]
    ds_read_b64_tr_b16 v[44:45], v20 offset:28288
    ds_read_b64_tr_b16 v[46:47], v21 offset:28288
    s_waitcnt lgkmcnt(4)
    v_mfma_f32_32x32x16_bf16 v[64:79], v[36:39], v[32:35], v[64:79]
    ds_read_b128 v[48:51], v17 offset:8192
    ds_read_b64_tr_b16 v[52:53], v22 offset:26112
    ds_read_b64_tr_b16 v[54:55], v23 offset:26112
    v_mfma_f32_4x4x4_16b_bf16 v[112:115], v[32:33], v[32:33], v[112:115]
    s_waitcnt lgkmcnt(5)
    v_mfma_f32_32x32x16_bf16 v[80:95], v[40:43], v[32:35], v[80:95]
    ds_read_b64_tr_b16 v[56:57], v22 offset:27200
    ds_read_b64_tr_b16 v[58:59], v23 offset:27200
    v_mfma_f32_4x4x4_16b_bf16 v[116:119], v[34:35], v[34:35], v[116:119]
    s_waitcnt lgkmcnt(5)
    v_mfma_f32_32x32x16_bf16 v[96:111], v[32:35], v[44:47], v[96:111]
    ds_read_b64_tr_b16 v[60:61], v22 offset:28288
    ds_read_b64_tr_b16 v[62:63], v23 offset:28288
    v_mfma_f32_4x4x4_16b_bf16 v[120:123], v[132:133], v[36:37], v[120:123]
    v_mfma_f32_4x4x4_16b_bf16 v[124:127], v[132:133], v[40:41], v[124:127]
    v_mfma_f32_4x4x4_16b_bf16 v[128:131], v[132:133], v[44:45], v[128:131]
    v_mfma_f32_4x4x4_16b_bf16 v[120:123], v[132:133], v[38:39], v[120:123]
    v_mfma_f32_4x4x4_16b_bf16 v[124:127], v[132:133], v[42:43], v[124:127]
    v_mfma_f32_4x4x4_16b_bf16 v[128:131], v[132:133], v[46:47], v[128:131]
    s_waitcnt lgkmcnt(4)
    v_mfma_f32_32x32x16_bf16 v[64:79], v[52:55], v[48:51], v[64:79]
    ds_read_b128 v[32:35], v18 offset:8192
    ds_read_b64_tr_b16 v[36:37], v24 offset:26112
    ds_read_b64_tr_b16 v[38:39], v25 offset:26112
    v_mfma_f32_4x4x4_16b_bf16 v[112:115], v[48:49], v[48:49], v[112:115]
    s_waitcnt lgkmcnt(5)
    v_mfma_f32_32x32x16_bf16 v[80:95], v[56:59], v[48:51], v[80:95]
    ds_read_b64_tr_b16 v[40:41], v24 offset:27200
    ds_read_b64_tr_b16 v[42:43], v25 offset:27200
    v_mfma_f32_4x4x4_16b_bf16 v[116:119], v[50:51], v[50:51], v[116:119]
    s_waitcnt lgkmcnt(5)
    v_mfma_f32_32x32x16_bf16 v[96:111], v[48:51], v[60:63], v[96:111]
    ds_read_b64_tr_b16 v[44:45], v24 offset:28288
    ds_read_b64_tr_b16 v[46:47], v25 offset:28288
    s_waitcnt lgkmcnt(4)
    v_mfma_f32_32x32x16_bf16 v[64:79], v[36:39], v[32:35], v[64:79]
    ds_read_b128 v[48:51], v19 offset:8192
    ds_read_b64_tr_b16 v[52:53], v26 offset:26112
    ds_read_b64_tr_b16 v[54:55], v27 offset:26112
    v_mfma_f32_4x4x4_16b_bf16 v[112:115], v[32:33], v[32:33], v[112:115]
    s_waitcnt lgkmcnt(5)
    v_mfma_f32_32x32x16_bf16 v[80:95], v[40:43], v[32:35], v[80:95]
    ds_read_b64_tr_b16 v[56:57], v26 offset:27200
    ds_read_b64_tr_b16 v[58:59], v27 offset:27200
    v_mfma_f32_4x4x4_16b_bf16 v[116:119], v[34:35], v[34:35], v[116:119]
    s_waitcnt lgkmcnt(5)
    v_mfma_f32_32x32x16_bf16 v[96:111], v[32:35], v[44:47], v[96:111]
    ds_read_b64_tr_b16 v[60:61], v26 offset:28288
    ds_read_b64_tr_b16 v[62:63], v27 offset:28288
    s_waitcnt lgkmcnt(4)
    v_mfma_f32_32x32x16_bf16 v[64:79], v[52:55], v[48:51], v[64:79]
    v_mfma_f32_4x4x4_16b_bf16 v[112:115], v[48:49], v[48:49], v[112:115]
    s_waitcnt lgkmcnt(2)
    v_mfma_f32_32x32x16_bf16 v[80:95], v[56:59], v[48:51], v[80:95]
    v_mfma_f32_4x4x4_16b_bf16 v[116:119], v[50:51], v[50:51], v[116:119]
    s_waitcnt lgkmcnt(0)
    v_mfma_f32_32x32x16_bf16 v[96:111], v[48:51], v[60:63], v[96:111]
    v_and_b32 v7, 31, v1
    v_lshlrev_b32 v3, 4, v7
    s_lshl_b32 s48, s3, 2
    v_add_u32 v4, s48, v3
    v_add_u32 v4, 160256, v4
    v_add_u32 v3, 160256, v3
    s_lshl_b32 s48, s3, 9
    s_add_u32 s48, s48, 161792
    v_lshl_add_u32 v5, v7, 2, s48
    v_lshrrev_b32 v6, 5, v1
    v_lshl_add_u32 v6, v6, 4, s48
    v_mov_b32 v121, v120
    v_mov_b32 v125, v124
    v_mov_b32 v129, v128
    v_permlane32_swap_b32 v120, v121
    v_permlane32_swap_b32 v124, v125
    v_permlane32_swap_b32 v128, v129
    v_add_f32 v120, v120, v121
    ds_write_b32 v4, v120 offset:0
    v_add_f32 v124, v124, v125
    ds_write_b32 v4, v124 offset:512
    v_add_f32 v128, v128, v129
    ds_write_b32 v4, v128 offset:1024
    v_add_f32 v112, v112, v116
    v_add_f32 v113, v113, v117
    v_add_f32 v114, v114, v118
    v_add_f32 v115, v115, v119
    v_and_b32 v7, 3, v1
    v_cmp_eq_u32 vcc, 1, v7
    v_cmp_eq_u32 s[56:57], 2, v7
    v_cmp_eq_u32 s[58:59], 3, v7
    v_cndmask_b32 v112, v112, v113, vcc
    v_cndmask_b32 v112, v112, v114, s[56:57]
    v_cndmask_b32 v112, v112, v115, s[58:59]
    v_mov_b32 v8, v76
    v_mov_b32 v9, v76
    v_mov_b32 v113, v112
    s_waitcnt lgkmcnt(0)
    s_barrier
    ds_read_b128 v[32:35], v3
    ds_read_b128 v[36:39], v3 offset:512
    ds_read_b128 v[40:43], v3 offset:1024
    v_permlane32_swap_b32 v8, v9
    v_permlane32_swap_b32 v112, v113
    v_mul_f32 v9, 0x3b124925, v9
    v_add_f32 v8, v112, v113
    v_mul_f32 v8, 0x3b124925, v8
    v_fma_f32 v8, -v9, v9, v8
    v_max_f32 v8, 0, v8
    v_add_f32 v8, 0x3727c5ac, v8
    v_rsq_f32 v8, v8
    s_nop 0
    v_mul_f32 v7, v8, v9
    ds_write_b32 v5, v8 offset:256
    ds_write_b32 v5, v7 offset:384
    s_waitcnt lgkmcnt(2)
    v_add_f32 v32, v32, v33
    v_add_f32 v34, v34, v35
    v_add_f32 v32, v32, v34
    v_add_f32 v36, v36, v37
    v_add_f32 v38, v38, v39
    v_add_f32 v36, v36, v38
    v_add_f32 v40, v40, v41
    v_add_f32 v42, v42, v43
    v_add_f32 v40, v40, v42
    ds_write_b32 v5, v32
    ds_write_b32 v5, v36 offset:128
    s_waitcnt lgkmcnt(0)
    ds_read_b128 v[144:147], v6 offset:128
    ds_read_b128 v[148:151], v6 offset:160
    ds_read_b128 v[152:155], v6 offset:192
    ds_read_b128 v[156:159], v6 offset:224
    ds_read_b128 v[160:163], v6 offset:256
    ds_read_b128 v[164:167], v6 offset:288
    ds_read_b128 v[168:171], v6 offset:320
    ds_read_b128 v[172:175], v6 offset:352
    ds_read_b128 v[176:179], v6 offset:384
    ds_read_b128 v[180:183], v6 offset:416
    ds_read_b128 v[184:187], v6 offset:448
    ds_read_b128 v[188:191], v6 offset:480
    ds_read_b128 v[192:195], v6 offset:0
    ds_read_b128 v[196:199], v6 offset:32
    ds_read_b128 v[200:203], v6 offset:64
    ds_read_b128 v[204:207], v6 offset:96
    v_mul_f32 v7, 0x3e8b97f6, v8
    s_lshl_b32 s50, s29, 6
    s_add_u32 s50, s50, s31
    s_lshl_b32 s51, s50, 12
    s_add_u32 s51, s51, 2097152
    s_lshl_b32 s50, s50, 7
    s_add_u32 s50, s50, 1048576
    s_lshl_b32 s48, s3, 12
    s_add_u32 s48, s48, 98304
    v_add_u32 v4, s48, v2
    v_and_b32 v3, 31, v1
    v_cmp_eq_u32 vcc, 28, v3
    v_mov_b32 v3, 0x3f803f80
    s_waitcnt lgkmcnt(12)
    v_fma_f32 v80, -v9, v144, v80
    v_fma_f32 v81, -v9, v145, v81
    v_fma_f32 v82, -v9, v146, v82
    v_fma_f32 v83, -v9, v147, v83
    v_fma_f32 v84, -v9, v148, v84
    v_fma_f32 v85, -v9, v149, v85
    v_fma_f32 v86, -v9, v150, v86
    v_fma_f32 v87, -v9, v151, v87
    v_fma_f32 v88, -v9, v152, v88
    v_fma_f32 v89, -v9, v153, v89
    v_fma_f32 v90, -v9, v154, v90
    v_fma_f32 v91, -v9, v155, v91
    v_fma_f32 v92, -v9, v156, v92
    v_fma_f32 v93, -v9, v157, v93
    v_fma_f32 v94, -v9, v158, v94
    v_fma_f32 v95, -v9, v159, v95
    v_mul_f32 v80, v8, v80
    v_mul_f32 v81, v8, v81
    v_mul_f32 v82, v8, v82
    v_mul_f32 v83, v8, v83
    v_mul_f32 v84, v8, v84
    v_mul_f32 v85, v8, v85
    v_mul_f32 v86, v8, v86
    v_mul_f32 v87, v8, v87
    v_mul_f32 v88, v8, v88
    v_mul_f32 v89, v8, v89
    v_mul_f32 v90, v8, v90
    v_mul_f32 v91, v8, v91
    v_mul_f32 v92, v8, v92
    v_mul_f32 v93, v8, v93
    v_mul_f32 v94, v8, v94
    v_mul_f32 v95, v8, v95
    v_cvt_pk_bf16_f32 v52, v80, v81
    v_cvt_pk_bf16_f32 v53, v82, v83
    v_cvt_pk_bf16_f32 v54, v84, v85
    v_cvt_pk_bf16_f32 v55, v86, v87
    v_cvt_pk_bf16_f32 v56, v88, v89
    v_cvt_pk_bf16_f32 v57, v90, v91
    v_cvt_pk_bf16_f32 v58, v92, v93
    v_cvt_pk_bf16_f32 v59, v94, v95
    buffer_store_dwordx4 v[52:55], v2, s[32:35], s51 offen sc1
    buffer_store_dwordx4 v[56:59], v2, s[32:35], s51 offen offset:1024 sc1
    s_waitcnt lgkmcnt(4)
    v_mul_f32 v96, v160, v96
    v_mul_f32 v97, v161, v97
    v_mul_f32 v98, v162, v98
    v_mul_f32 v99, v163, v99
    v_mul_f32 v100, v164, v100
    v_mul_f32 v101, v165, v101
    v_mul_f32 v102, v166, v102
    v_mul_f32 v103, v167, v103
    v_mul_f32 v104, v168, v104
    v_mul_f32 v105, v169, v105
    v_mul_f32 v106, v170, v106
    v_mul_f32 v107, v171, v107
    v_mul_f32 v108, v172, v108
    v_mul_f32 v109, v173, v109
    v_mul_f32 v110, v174, v110
    v_mul_f32 v111, v175, v111
    v_fma_f32 v96, -v176, v40, v96
    v_fma_f32 v97, -v177, v40, v97
    v_fma_f32 v98, -v178, v40, v98
    v_fma_f32 v99, -v179, v40, v99
    v_fma_f32 v100, -v180, v40, v100
    v_fma_f32 v101, -v181, v40, v101
    v_fma_f32 v102, -v182, v40, v102
    v_fma_f32 v103, -v183, v40, v103
    v_fma_f32 v104, -v184, v40, v104
    v_fma_f32 v105, -v185, v40, v105
    v_fma_f32 v106, -v186, v40, v106
    v_fma_f32 v107, -v187, v40, v107
    v_fma_f32 v108, -v188, v40, v108
    v_fma_f32 v109, -v189, v40, v109
    v_fma_f32 v110, -v190, v40, v110
    v_fma_f32 v111, -v191, v40, v111
    v_cvt_pk_bf16_f32 v44, v96, v97
    v_cvt_pk_bf16_f32 v45, v98, v99
    v_cvt_pk_bf16_f32 v46, v100, v101
    v_cvt_pk_bf16_f32 v47, v102, v103
    v_cvt_pk_bf16_f32 v48, v104, v105
    v_cvt_pk_bf16_f32 v49, v106, v107
    v_cvt_pk_bf16_f32 v50, v108, v109
    v_cvt_pk_bf16_f32 v51, v110, v111
    v_cndmask_b32 v44, v44, v3, vcc
    v_cndmask_b32 v45, v45, v3, vcc
    v_cndmask_b32 v46, v46, v3, vcc
    v_cndmask_b32 v47, v47, v3, vcc
    v_cndmask_b32 v48, v48, v3, vcc
    v_cndmask_b32 v49, v49, v3, vcc
    v_cndmask_b32 v50, v50, v3, vcc
    v_cndmask_b32 v51, v51, v3, vcc
    buffer_store_dwordx4 v[44:47], v2, s[32:35], s51 offen offset:2048 sc1
    buffer_store_dwordx4 v[48:51], v2, s[32:35], s51 offen offset:3072 sc1
    ds_write_b128 v4, v[52:55]
    ds_write_b128 v4, v[56:59] offset:1024
    ds_write_b128 v4, v[44:47] offset:2048
    ds_write_b128 v4, v[48:51] offset:3072
    s_waitcnt lgkmcnt(4)
    v_fma_f32 v64, -v9, v192, v64
    v_fma_f32 v65, -v9, v193, v65
    v_fma_f32 v66, -v9, v194, v66
    v_fma_f32 v67, -v9, v195, v67
    v_fma_f32 v68, -v9, v196, v68
    v_fma_f32 v69, -v9, v197, v69
    v_fma_f32 v70, -v9, v198, v70
    v_fma_f32 v71, -v9, v199, v71
    v_fma_f32 v72, -v9, v200, v72
    v_fma_f32 v73, -v9, v201, v73
    v_fma_f32 v74, -v9, v202, v74
    v_fma_f32 v75, -v9, v203, v75
    v_fma_f32 v76, -v9, v204, v76
    v_fma_f32 v77, -v9, v205, v77
    v_fma_f32 v78, -v9, v206, v78
    v_fma_f32 v79, -v9, v207, v79
    v_mul_f32 v64, v7, v64
    v_mul_f32 v65, v7, v65
    v_mul_f32 v66, v7, v66
    v_mul_f32 v67, v7, v67
    v_mul_f32 v68, v7, v68
    v_mul_f32 v69, v7, v69
    v_mul_f32 v70, v7, v70
    v_mul_f32 v71, v7, v71
    v_mul_f32 v72, v7, v72
    v_mul_f32 v73, v7, v73
    v_mul_f32 v74, v7, v74
    v_mul_f32 v75, v7, v75
    v_mul_f32 v76, v7, v76
    v_mul_f32 v77, v7, v77
    v_mul_f32 v78, v7, v78
    v_mul_f32 v79, v7, v79
    v_cvt_pk_bf16_f32 v208, v64, v65
    v_cvt_pk_bf16_f32 v209, v66, v67
    v_cvt_pk_bf16_f32 v210, v68, v69
    v_cvt_pk_bf16_f32 v211, v70, v71
    v_cvt_pk_bf16_f32 v212, v72, v73
    v_cvt_pk_bf16_f32 v213, v74, v75
    v_cvt_pk_bf16_f32 v214, v76, v77
    v_cvt_pk_bf16_f32 v215, v78, v79
    s_waitcnt vmcnt(0)
    v_mov_b32 v3, s26
    v_mov_b32 v4, 0
    s_mov_b64 exec, 1
    buffer_store_dword v3, v4, s[32:35], s50 offen sc1
    s_mov_b64 exec, -1
    s_mov_b32 s98, 0
sequential_preLN__sliding_block__mixer_token_mlp__prompt_kernel_xt6:
    v_xor_b32 v140, s11, v140
    v_and_b32 v3, 0xfffffff, v140
    v_cmp_ne_u32 vcc, 0, v3
    s_cmp_gt_u32 s98, 30000
    s_cbranch_scc1 sequential_preLN__sliding_block__mixer_token_mlp__prompt_kernel_xtd7
    s_cbranch_vccz sequential_preLN__sliding_block__mixer_token_mlp__prompt_kernel_xtd7
    buffer_load_dword v140, v141, s[32:35], s63 offen sc1
    s_add_u32 s98, s98, 1
    s_waitcnt vmcnt(0)
    s_branch sequential_preLN__sliding_block__mixer_token_mlp__prompt_kernel_xt6
sequential_preLN__sliding_block__mixer_token_mlp__prompt_kernel_xtd7:
    v_cmp_ne_u32 vcc, 0, v140
    s_cmp_eq_u64 vcc, 0
    s_cselect_b32 s11, 1, 0
    s_lshl_b32 s50, s29, 18
    s_add_u32 s50, s50, 2097152
    s_lshl_b32 s51, s30, 2
    s_lshl_b32 s52, s3, 1
    s_add_u32 s51, s51, s52
    s_sub_u32 s51, s51, 8
    s_lshl_b32 s52, s51, 12
    v_add_u32 v5, s52, v2
    v_add_u32 v6, 4096, v5
    s_lshl_b32 s52, s29, 6
    s_add_u32 s52, s52, s51
    s_lshl_b32 s52, s52, 7
    s_add_u32 s52, s52, 1048576
    v_and_b32 v8, 1, v1
    v_lshlrev_b32 v8, 7, v8
    v_and_b32 v9, 31, v1
    v_lshrrev_b32 v7, 5, v1
    v_lshlrev_b32 v7, 2, v7
    v_sub_u32 v9, v9, v7
    s_sub_u32 s63, 8, s31
    s_max_i32 s63, s63, 0
    s_lshl_b32 s53, s3, 12
    s_add_u32 s53, s53, 65536
    v_add_u32 v7, s53, v2
    s_lshl_b32 s53, s3, 13
    s_add_u32 s53, s53, 65536
    s_add_u32 s40, s24, s50
    s_addc_u32 s41, s25, 0
    s_mov_b32 s42, 262144
    s_mov_b32 s43, 0x20000
    v_cmp_le_i32 s[64:65], 0, v9
    v_cmp_le_i32 s[66:67], 1, v9
    v_cmp_le_i32 s[68:69], 2, v9
    v_cmp_le_i32 s[70:71], 3, v9
    v_cmp_le_i32 s[72:73], 8, v9
    v_cmp_le_i32 s[74:75], 9, v9
    v_cmp_le_i32 s[76:77], 10, v9
    v_cmp_le_i32 s[78:79], 11, v9
    v_cmp_le_i32 s[80:81], 16, v9
    v_cmp_le_i32 s[82:83], 17, v9
    v_cmp_le_i32 s[84:85], 18, v9
    v_cmp_le_i32 s[86:87], 19, v9
    v_cmp_le_i32 s[88:89], 24, v9
    v_cmp_le_i32 s[90:91], 25, v9
    v_cmp_le_i32 s[92:93], 26, v9
    v_cmp_le_i32 s[94:95], 27, v9
    v_mov_b32 v3, 0xffff
    v_mov_b32 v4, 0xffff0000
    v_cndmask_b32 v9, 0, v3, s[64:65]
    v_cndmask_b32 v216, 0, v4, s[66:67]
    v_or_b32 v216, v9, v216
    v_cndmask_b32 v9, 0, v3, s[68:69]
    v_cndmask_b32 v217, 0, v4, s[70:71]
    v_or_b32 v217, v9, v217
    v_cndmask_b32 v9, 0, v3, s[72:73]
    v_cndmask_b32 v218, 0, v4, s[74:75]
    v_or_b32 v218, v9, v218
    v_cndmask_b32 v9, 0, v3, s[76:77]
    v_cndmask_b32 v219, 0, v4, s[78:79]
    v_or_b32 v219, v9, v219
    v_cndmask_b32 v9, 0, v3, s[80:81]
    v_cndmask_b32 v220, 0, v4, s[82:83]
    v_or_b32 v220, v9, v220
    v_cndmask_b32 v9, 0, v3, s[84:85]
    v_cndmask_b32 v221, 0, v4, s[86:87]
    v_or_b32 v221, v9, v221
    v_cndmask_b32 v9, 0, v3, s[88:89]
    v_cndmask_b32 v222, 0, v4, s[90:91]
    v_or_b32 v222, v9, v222
    v_cndmask_b32 v9, 0, v3, s[92:93]
    v_cndmask_b32 v223, 0, v4, s[94:95]
    v_or_b32 v223, v9, v223
    s_cmp_lt_i32 s51, 0
    s_cbranch_scc1 sequential_preLN__sliding_block__mixer_token_mlp__prompt_kernel_nopoll8
    s_mov_b32 s98, 0
    s_mov_b32 s58, 0x3
    s_mov_b32 s59, 0
sequential_preLN__sliding_block__mixer_token_mlp__prompt_kernel_poll9:
    s_mov_b64 exec, s[58:59]
    buffer_load_dword v3, v8, s[32:35], s52 offen sc1
    s_waitcnt vmcnt(0)
    v_cmp_ne_u32 s[58:59], s26, v3
    s_ff1_i32_b32 s99, s58
    s_cmp_lt_i32 s99, 0
    s_cbranch_scc1 sequential_preLN__sliding_block__mixer_token_mlp__prompt_kernel_got11
    s_lshl_b64 exec, 1, s99
    s_andn2_b64 s[58:59], s[58:59], exec
sequential_preLN__sliding_block__mixer_token_mlp__prompt_kernel_one10:
    buffer_load_dword v3, v8, s[32:35], s52 offen sc1
    s_add_u32 s98, s98, 1
    s_waitcnt vmcnt(0)
    v_cmp_ne_u32 vcc, s26, v3
    s_cmp_gt_u32 s98, 30000
    s_cbranch_scc1 sequential_preLN__sliding_block__mixer_token_mlp__prompt_kernel_got11
    s_cbranch_vccnz sequential_preLN__sliding_block__mixer_token_mlp__prompt_kernel_one10
    s_cmp_lg_u32 s58, 0
    s_cbranch_scc1 sequential_preLN__sliding_block__mixer_token_mlp__prompt_kernel_poll9
sequential_preLN__sliding_block__mixer_token_mlp__prompt_kernel_got11:
    s_mov_b64 exec, -1
sequential_preLN__sliding_block__mixer_token_mlp__prompt_kernel_nopoll8:
    s_waitcnt vmcnt(0)
    s_add_u32 m0, s53, 0
    s_nop 0
    buffer_load_dwordx4 v5, s[40:43], 0 offen offset:0 sc1 lds
    buffer_load_dwordx4 v5, s[40:43], 0 offen offset:1024 sc1 lds
    buffer_load_dwordx4 v5, s[40:43], 0 offen offset:2048 sc1 lds
    buffer_load_dwordx4 v5, s[40:43], 0 offen offset:3072 sc1 lds
    s_add_u32 m0, s53, 4096
    s_nop 0
    buffer_load_dwordx4 v6, s[40:43], 0 offen offset:0 sc1 lds
    buffer_load_dwordx4 v6, s[40:43], 0 offen offset:1024 sc1 lds
    buffer_load_dwordx4 v6, s[40:43], 0 offen offset:2048 sc1 lds
    buffer_load_dwordx4 v6, s[40:43], 0 offen offset:3072 sc1 lds
    s_mul_i32 s50, s3, 100352
    s_lshl_b32 s51, s60, 7
    s_add_u32 s50, s50, s51
    s_sub_u32 s51, 401408, s50
    s_add_u32 s36, s8, s50
    s_addc_u32 s37, s9, 0
    s_mov_b32 s38, s51
    s_mov_b32 s39, 0x20000
    v_lshrrev_b32 v3, 3, v1
    v_mul_u32_u24 v3, 896, v3
    v_and_b32 v4, 7, v1
    v_bfe_u32 v5, v1, 4, 1
    v_lshlrev_b32 v5, 2, v5
    v_xor_b32 v4, v4, v5
    v_lshl_add_u32 v10, v4, 4, v3
    v_add_u32 v11, 6144, v10
    s_mov_b32 s40, s12
    s_mov_b32 s41, s13
    s_mov_b32 s42, 7340032
    s_mov_b32 s43, 0x20000
    s_waitcnt vmcnt(0)
    s_waitcnt lgkmcnt(0)
    s_barrier
    ds_read_b128 v[16:19], v7 offset:0
    ds_read_b128 v[20:23], v7 offset:1024
    ds_read_b128 v[24:27], v7 offset:32768
    ds_read_b128 v[28:31], v7 offset:33792
    s_waitcnt lgkmcnt(2)
    s_cmp_gt_i32 s63, 0
    s_cbranch_scc1 sequential_preLN__sliding_block__mixer_token_mlp__prompt_kernel_inv12
    v_mfma_f32_32x32x16_bf16 v[64:79], v[16:19], v[208:211], 0
    v_mfma_f32_32x32x16_bf16 v[64:79], v[20:23], v[212:215], v[64:79]
sequential_preLN__sliding_block__mixer_token_mlp__prompt_kernel_back13:
    v_mul_u32_u24 v6, 37, v1
    v_lshrrev_b32 v6, 8, v6
    v_mul_u32_u24 v6, 228480, v6
    v_lshl_add_u32 v6, v1, 7, v6
    s_mov_b32 exec_lo, 0xffffc000
    s_mov_b32 exec_hi, 0xffffff
    buffer_load_dword v9, v6, s[40:43], s54 offen
    s_mov_b64 exec, -1
    s_add_u32 m0, s96, 0
    s_mov_b32 s48, 0
    buffer_load_dwordx4 v244, s[44:47], s48 offen lds
    buffer_load_dwordx4 v245, s[44:47], s48 offen offset:1024 lds
    ds_read_b128 v[16:19], v7 offset:4096
    ds_read_b128 v[20:23], v7 offset:5120
    s_waitcnt lgkmcnt(2)
    v_mfma_f32_32x32x16_bf16 v[192:207], v[24:27], v[208:211], 0
    v_mfma_f32_32x32x16_bf16 v[192:207], v[28:31], v[212:215], v[192:207]
    s_add_u32 m0, s96, 2048
    s_mov_b32 s48, 57344
    buffer_load_dwordx4 v244, s[44:47], s48 offen lds
    buffer_load_dwordx4 v245, s[44:47], s48 offen offset:1024 lds
    ds_read_b128 v[24:27], v7 offset:8192
    ds_read_b128 v[28:31], v7 offset:9216
    s_waitcnt lgkmcnt(2)
    s_cmp_gt_i32 s63, 1
    s_cbranch_scc1 sequential_preLN__sliding_block__mixer_token_mlp__prompt_kernel_inv14
    v_mfma_f32_32x32x16_bf16 v[80:95], v[16:19], v[208:211], 0
    v_mfma_f32_32x32x16_bf16 v[80:95], v[20:23], v[212:215], v[80:95]
sequential_preLN__sliding_block__mixer_token_mlp__prompt_kernel_back15:
    s_add_u32 m0, s96, 4096
    s_mov_b32 s48, 114688
    buffer_load_dwordx4 v244, s[44:47], s48 offen lds
    buffer_load_dwordx4 v245, s[44:47], s48 offen offset:1024 lds
    ds_read_b128 v[16:19], v7 offset:12288
    ds_read_b128 v[20:23], v7 offset:13312
    s_waitcnt lgkmcnt(2)
    s_cmp_gt_i32 s63, 2
    s_cbranch_scc1 sequential_preLN__sliding_block__mixer_token_mlp__prompt_kernel_inv16
    v_mfma_f32_32x32x16_bf16 v[96:111], v[24:27], v[208:211], 0
    v_mfma_f32_32x32x16_bf16 v[96:111], v[28:31], v[212:215], v[96:111]
sequential_preLN__sliding_block__mixer_token_mlp__prompt_kernel_back17:
    s_add_u32 m0, s96, 6144
    s_mov_b32 s48, 172032
    buffer_load_dwordx4 v244, s[44:47], s48 offen lds
    buffer_load_dwordx4 v245, s[44:47], s48 offen offset:1024 lds
    v_cndmask_b32 v64, v64, v192, s[64:65]
    v_cndmask_b32 v65, v65, v193, s[66:67]
    v_cndmask_b32 v66, v66, v194, s[68:69]
    v_cndmask_b32 v67, v67, v195, s[70:71]
    v_cndmask_b32 v68, v68, v196, s[72:73]
    v_cndmask_b32 v69, v69, v197, s[74:75]
    v_cndmask_b32 v70, v70, v198, s[76:77]
    v_cndmask_b32 v71, v71, v199, s[78:79]
    v_cndmask_b32 v72, v72, v200, s[80:81]
    v_cndmask_b32 v73, v73, v201, s[82:83]
    v_cndmask_b32 v74, v74, v202, s[84:85]
    v_cndmask_b32 v75, v75, v203, s[86:87]
    v_cndmask_b32 v76, v76, v204, s[88:89]
    v_cndmask_b32 v77, v77, v205, s[90:91]
    v_cndmask_b32 v78, v78, v206, s[92:93]
    v_cndmask_b32 v79, v79, v207, s[94:95]
    ds_read_b128 v[24:27], v7 offset:16384
    ds_read_b128 v[28:31], v7 offset:17408
    s_waitcnt lgkmcnt(2)
    s_cmp_gt_i32 s63, 3
    s_cbranch_scc1 sequential_preLN__sliding_block__mixer_token_mlp__prompt_kernel_inv18
    v_mfma_f32_32x32x16_bf16 v[112:127], v[16:19], v[208:211], 0
    v_mfma_f32_32x32x16_bf16 v[112:127], v[20:23], v[212:215], v[112:127]
sequential_preLN__sliding_block__mixer_token_mlp__prompt_kernel_back19:
    s_add_u32 m0, s96, 8192
    s_mov_b32 s48, 229376
    buffer_load_dwordx4 v244, s[44:47], s48 offen lds
    buffer_load_dwordx4 v245, s[44:47], s48 offen offset:1024 lds
    v_max_f32 v4, v64, v65
    v_max3_f32 v4, v66, v67, v4
    v_max3_f32 v4, v68, v69, v4
    v_max3_f32 v4, v70, v71, v4
    v_max3_f32 v4, v72, v73, v4
    v_max3_f32 v4, v74, v75, v4
    v_max3_f32 v4, v76, v77, v4
    v_max3_f32 v4, v78, v79, v4
    v_max3_f32 v4, v80, v81, v4
    v_max3_f32 v4, v82, v83, v4
    v_max3_f32 v4, v84, v85, v4
    v_max3_f32 v4, v86, v87, v4
    v_max3_f32 v4, v88, v89, v4
    v_max3_f32 v4, v90, v91, v4
    v_max3_f32 v4, v92, v93, v4
    v_max3_f32 v4, v94, v95, v4
    ds_read_b128 v[16:19], v7 offset:20480
    ds_read_b128 v[20:23], v7 offset:21504
    s_waitcnt lgkmcnt(2)
    s_cmp_gt_i32 s63, 4
    s_cbranch_scc1 sequential_preLN__sliding_block__mixer_token_mlp__prompt_kernel_inv20
    v_mfma_f32_32x32x16_bf16 v[128:143], v[24:27], v[208:211], 0
    v_mfma_f32_32x32x16_bf16 v[128:143], v[28:31], v[212:215], v[128:143]
sequential_preLN__sliding_block__mixer_token_mlp__prompt_kernel_back21:
    s_add_u32 m0, s96, 10240
    s_mov_b32 s48, 286720
    buffer_load_dwordx4 v244, s[44:47], s48 offen lds
    buffer_load_dwordx4 v245, s[44:47], s48 offen offset:1024 lds
    v_max3_f32 v4, v96, v97, v4
    v_max3_f32 v4, v98, v99, v4
    v_max3_f32 v4, v100, v101, v4
    v_max3_f32 v4, v102, v103, v4
    v_max3_f32 v4, v104, v105, v4
    v_max3_f32 v4, v106, v107, v4
    v_max3_f32 v4, v108, v109, v4
    v_max3_f32 v4, v110, v111, v4
    ds_read_b128 v[24:27], v7 offset:24576
    ds_read_b128 v[28:31], v7 offset:25600
    s_waitcnt lgkmcnt(2)
    s_cmp_gt_i32 s63, 5
    s_cbranch_scc1 sequential_preLN__sliding_block__mixer_token_mlp__prompt_kernel_inv22
    v_mfma_f32_32x32x16_bf16 v[144:159], v[16:19], v[208:211], 0
    v_mfma_f32_32x32x16_bf16 v[144:159], v[20:23], v[212:215], v[144:159]
sequential_preLN__sliding_block__mixer_token_mlp__prompt_kernel_back23:
    s_add_u32 m0, s97, 0
    s_mov_b32 s48, 0
    buffer_load_dwordx4 v10, s[36:39], s48 offen lds
    buffer_load_dwordx4 v11, s[36:39], s48 offen offset:1024 lds
    v_max3_f32 v4, v112, v113, v4
    v_max3_f32 v4, v114, v115, v4
    v_max3_f32 v4, v116, v117, v4
    v_max3_f32 v4, v118, v119, v4
    v_max3_f32 v4, v120, v121, v4
    v_max3_f32 v4, v122, v123, v4
    v_max3_f32 v4, v124, v125, v4
    v_max3_f32 v4, v126, v127, v4
    ds_read_b128 v[16:19], v7 offset:28672
    ds_read_b128 v[20:23], v7 offset:29696
    s_waitcnt lgkmcnt(2)
    s_cmp_gt_i32 s63, 6
    s_cbranch_scc1 sequential_preLN__sliding_block__mixer_token_mlp__prompt_kernel_inv24
    v_mfma_f32_32x32x16_bf16 v[160:175], v[24:27], v[208:211], 0
    v_mfma_f32_32x32x16_bf16 v[160:175], v[28:31], v[212:215], v[160:175]
sequential_preLN__sliding_block__mixer_token_mlp__prompt_kernel_back25:
    s_add_u32 m0, s97, 2048
    s_mov_b32 s48, 14336
    buffer_load_dwordx4 v10, s[36:39], s48 offen lds
    buffer_load_dwordx4 v11, s[36:39], s48 offen offset:1024 lds
    v_max3_f32 v4, v128, v129, v4
    v_max3_f32 v4, v130, v131, v4
    v_max3_f32 v4, v132, v133, v4
    v_max3_f32 v4, v134, v135, v4
    v_max3_f32 v4, v136, v137, v4
    v_max3_f32 v4, v138, v139, v4
    v_max3_f32 v4, v140, v141, v4
    v_max3_f32 v4, v142, v143, v4
    s_waitcnt lgkmcnt(0)
    s_cmp_gt_i32 s63, 7
    s_cbranch_scc1 sequential_preLN__sliding_block__mixer_token_mlp__prompt_kernel_inv26
    v_mfma_f32_32x32x16_bf16 v[176:191], v[16:19], v[208:211], 0
    v_mfma_f32_32x32x16_bf16 v[176:191], v[20:23], v[212:215], v[176:191]
sequential_preLN__sliding_block__mixer_token_mlp__prompt_kernel_back27:
    s_add_u32 m0, s97, 4096
    s_mov_b32 s48, 25088
    buffer_load_dwordx4 v10, s[36:39], s48 offen lds
    buffer_load_dwordx4 v11, s[36:39], s48 offen offset:1024 lds
    v_max3_f32 v4, v144, v145, v4
    v_max3_f32 v4, v146, v147, v4
    v_max3_f32 v4, v148, v149, v4
    v_max3_f32 v4, v150, v151, v4
    v_max3_f32 v4, v152, v153, v4
    v_max3_f32 v4, v154, v155, v4
    v_max3_f32 v4, v156, v157, v4
    v_max3_f32 v4, v158, v159, v4
    ds_read_b128 v[32:35], v7 offset:6144
    ds_read_b128 v[36:39], v7 offset:7168
    v_max3_f32 v4, v160, v161, v4
    v_max3_f32 v4, v162, v163, v4
    v_max3_f32 v4, v164, v165, v4
    v_max3_f32 v4, v166, v167, v4
    v_max3_f32 v4, v168, v169, v4
    v_max3_f32 v4, v170, v171, v4
    v_max3_f32 v4, v172, v173, v4
    v_max3_f32 v4, v174, v175, v4
    v_max3_f32 v4, v176, v177, v4
    v_max3_f32 v4, v178, v179, v4
    v_max3_f32 v4, v180, v181, v4
    v_max3_f32 v4, v182, v183, v4
    v_max3_f32 v4, v184, v185, v4
    v_max3_f32 v4, v186, v187, v4
    v_max3_f32 v4, v188, v189, v4
    v_max3_f32 v4, v190, v191, v4
    v_mov_b32 v5, v4
    s_nop 1
    v_permlane32_swap_b32 v4, v5
    v_max_f32 v4, v4, v5
    v_sub_f32 v4, 0, v4
    v_mov_b32 v5, v4
    v_pk_add_f32 v[80:81], v[80:81], v[4:5]
    v_exp_f32 v80, v80
    v_exp_f32 v81, v81
    s_add_u32 m0, s97, 6144
    s_mov_b32 s48, 39424
    buffer_load_dwordx4 v10, s[36:39], s48 offen lds
    buffer_load_dwordx4 v11, s[36:39], s48 offen offset:1024 lds
    v_pk_add_f32 v[82:83], v[82:83], v[4:5]
    v_cvt_pk_bf16_f32 v48, v80, v81
    v_exp_f32 v82, v82
    v_exp_f32 v83, v83
    v_pk_add_f32 v[84:85], v[84:85], v[4:5]
    v_cvt_pk_bf16_f32 v49, v82, v83
    v_exp_f32 v84, v84
    v_exp_f32 v85, v85
    v_pk_add_f32 v[86:87], v[86:87], v[4:5]
    v_cvt_pk_bf16_f32 v50, v84, v85
    v_exp_f32 v86, v86
    v_exp_f32 v87, v87
    v_pk_add_f32 v[88:89], v[88:89], v[4:5]
    v_cvt_pk_bf16_f32 v51, v86, v87
    v_exp_f32 v88, v88
    v_exp_f32 v89, v89
    v_pk_add_f32 v[90:91], v[90:91], v[4:5]
    v_cvt_pk_bf16_f32 v52, v88, v89
    v_exp_f32 v90, v90
    v_exp_f32 v91, v91
    v_pk_add_f32 v[92:93], v[92:93], v[4:5]
    v_cvt_pk_bf16_f32 v53, v90, v91
    v_exp_f32 v92, v92
    v_exp_f32 v93, v93
    s_add_u32 m0, s97, 8192
    s_mov_b32 s48, 50176
    buffer_load_dwordx4 v10, s[36:39], s48 offen lds
    buffer_load_dwordx4 v11, s[36:39], s48 offen offset:1024 lds
    v_pk_add_f32 v[94:95], v[94:95], v[4:5]
    v_cvt_pk_bf16_f32 v54, v92, v93
    v_exp_f32 v94, v94
    v_exp_f32 v95, v95
    s_nop 0
    v_cvt_pk_bf16_f32 v55, v94, v95
    ds_read_b128 v[40:43], v7 offset:10240
    ds_read_b128 v[44:47], v7 offset:11264
    v_pk_add_f32 v[96:97], v[96:97], v[4:5]
    v_exp_f32 v96, v96
    v_exp_f32 v97, v97
    s_add_u32 m0, s97, 10240
    s_mov_b32 s48, 64512
    buffer_load_dwordx4 v10, s[36:39], s48 offen lds
    buffer_load_dwordx4 v11, s[36:39], s48 offen offset:1024 lds
    v_pk_add_f32 v[98:99], v[98:99], v[4:5]
    v_cvt_pk_bf16_f32 v56, v96, v97
    v_exp_f32 v98, v98
    v_exp_f32 v99, v99
    s_waitcnt lgkmcnt(2)
    v_mfma_f32_32x32x16_bf16 v[224:239], v[32:35], v[48:51], 0
    v_pk_add_f32 v[100:101], v[100:101], v[4:5]
    v_cvt_pk_bf16_f32 v57, v98, v99
    v_exp_f32 v100, v100
    v_exp_f32 v101, v101
    s_waitcnt vmcnt(22)
    ds_read_b64_tr_b16 a[0:1], v240 offset:0
    ds_read_b64_tr_b16 a[2:3], v240 offset:512
    ds_read_b64_tr_b16 a[4:5], v241 offset:0
    ds_read_b64_tr_b16 a[6:7], v241 offset:512
    v_pk_add_f32 v[102:103], v[102:103], v[4:5]
    v_cvt_pk_bf16_f32 v58, v100, v101
    v_exp_f32 v102, v102
    v_exp_f32 v103, v103
    v_mfma_f32_32x32x16_bf16 v[224:239], v[36:39], v[52:55], v[224:239]
    v_pk_add_f32 v[104:105], v[104:105], v[4:5]
    v_cvt_pk_bf16_f32 v59, v102, v103
    v_exp_f32 v104, v104
    v_exp_f32 v105, v105
    v_pk_add_f32 v[106:107], v[106:107], v[4:5]
    v_cvt_pk_bf16_f32 v60, v104, v105
    v_exp_f32 v106, v106
    v_exp_f32 v107, v107
    s_waitcnt lgkmcnt(0)
    s_add_u32 m0, s96, 0
    s_mov_b32 s48, 344064
    buffer_load_dwordx4 v244, s[44:47], s48 offen lds
    buffer_load_dwordx4 v245, s[44:47], s48 offen offset:1024 lds
    s_waitcnt vmcnt(22)
    ds_read_b64_tr_b16 a[8:9], v240 offset:2048
    ds_read_b64_tr_b16 a[10:11], v240 offset:2560
    ds_read_b64_tr_b16 a[12:13], v241 offset:2048
    ds_read_b64_tr_b16 a[14:15], v241 offset:2560
    v_pk_add_f32 v[108:109], v[108:109], v[4:5]
    v_cvt_pk_bf16_f32 v61, v106, v107
    v_exp_f32 v108, v108
    v_exp_f32 v109, v109
    s_add_u32 m0, s97, 12288
    s_mov_b32 s48, 75264
    buffer_load_dwordx4 v10, s[36:39], s48 offen lds
    buffer_load_dwordx4 v11, s[36:39], s48 offen offset:1024 lds
    v_pk_add_f32 v[110:111], v[110:111], v[4:5]
    v_cvt_pk_bf16_f32 v62, v108, v109
    v_exp_f32 v110, v110
    v_exp_f32 v111, v111
    s_nop 0
    v_cvt_pk_bf16_f32 v63, v110, v111
    ds_read_b128 v[32:35], v7 offset:14336
    ds_read_b128 v[36:39], v7 offset:15360
    v_pk_add_f32 v[112:113], v[112:113], v[4:5]
    v_exp_f32 v112, v112
    v_exp_f32 v113, v113
    s_add_u32 m0, s97, 14336
    s_mov_b32 s48, 89600
    buffer_load_dwordx4 v10, s[36:39], s48 offen lds
    buffer_load_dwordx4 v11, s[36:39], s48 offen offset:1024 lds
    v_pk_add_f32 v[114:115], v[114:115], v[4:5]
    v_cvt_pk_bf16_f32 v48, v112, v113
    v_exp_f32 v114, v114
    v_exp_f32 v115, v115
    v_mfma_f32_32x32x16_bf16 v[224:239], v[40:43], v[56:59], v[224:239]
    v_pk_add_f32 v[116:117], v[116:117], v[4:5]
    v_cvt_pk_bf16_f32 v49, v114, v115
    v_exp_f32 v116, v116
    v_exp_f32 v117, v117
    s_waitcnt lgkmcnt(2)
    s_add_u32 m0, s96, 2048
    s_mov_b32 s48, 401408
    buffer_load_dwordx4 v244, s[44:47], s48 offen lds
    buffer_load_dwordx4 v245, s[44:47], s48 offen offset:1024 lds
    s_waitcnt vmcnt(26)
    ds_read_b64_tr_b16 a[16:17], v240 offset:4096
    ds_read_b64_tr_b16 a[18:19], v240 offset:4608
    ds_read_b64_tr_b16 a[20:21], v241 offset:4096
    ds_read_b64_tr_b16 a[22:23], v241 offset:4608
    v_pk_add_f32 v[118:119], v[118:119], v[4:5]
    v_cvt_pk_bf16_f32 v50, v116, v117
    v_exp_f32 v118, v118
    v_exp_f32 v119, v119
    v_mfma_f32_32x32x16_bf16 v[224:239], v[44:47], v[60:63], v[224:239]
    v_pk_add_f32 v[120:121], v[120:121], v[4:5]
    v_cvt_pk_bf16_f32 v51, v118, v119
    v_exp_f32 v120, v120
    v_exp_f32 v121, v121
    v_pk_add_f32 v[122:123], v[122:123], v[4:5]
    v_cvt_pk_bf16_f32 v52, v120, v121
    v_exp_f32 v122, v122
    v_exp_f32 v123, v123
    s_waitcnt lgkmcnt(0)
    s_add_u32 m0, s96, 4096
    s_mov_b32 s48, 458752
    buffer_load_dwordx4 v244, s[44:47], s48 offen lds
    buffer_load_dwordx4 v245, s[44:47], s48 offen offset:1024 lds
    s_waitcnt vmcnt(26)
    ds_read_b64_tr_b16 a[24:25], v240 offset:6144
    ds_read_b64_tr_b16 a[26:27], v240 offset:6656
    ds_read_b64_tr_b16 a[28:29], v241 offset:6144
    ds_read_b64_tr_b16 a[30:31], v241 offset:6656
    v_pk_add_f32 v[124:125], v[124:125], v[4:5]
    v_cvt_pk_bf16_f32 v53, v122, v123
    v_exp_f32 v124, v124
    v_exp_f32 v125, v125
    s_lshl_b32 s50, s61, 1
    s_lshr_b32 s51, s3, 1
    s_add_u32 s50, s50, s51
    s_mul_i32 s50, s50, 28672
    s_lshl_b32 s51, s60, 1
    s_add_u32 s51, s51, s55
    s_lshl_b32 s51, s51, 6
    s_add_u32 s50, s50, s51
    v_and_b32 v3, 31, v1
    v_lshrrev_b32 v6, 5, v1
    v_mul_u32_u24 v3, 896, v3
    v_lshl_add_u32 v3, v6, 4, v3
    s_mov_b32 s36, s4
    s_mov_b32 s37, s5
    s_mov_b32 s38, 1835008
    s_mov_b32 s39, 0x20000
    buffer_load_dwordx4 v[8:11], v3, s[36:39], s50 offen offset:0
    buffer_load_dwordx4 v[12:15], v3, s[36:39], s50 offen offset:32
    v_pk_add_f32 v[126:127], v[126:127], v[4:5]
    v_cvt_pk_bf16_f32 v54, v124, v125
    v_exp_f32 v126, v126
    v_exp_f32 v127, v127
    s_nop 0
    v_cvt_pk_bf16_f32 v55, v126, v127
    ds_read_b128 v[40:43], v7 offset:18432
    ds_read_b128 v[44:47], v7 offset:19456
    v_pk_add_f32 v[128:129], v[128:129], v[4:5]
    v_exp_f32 v128, v128
    v_exp_f32 v129, v129
    v_pk_add_f32 v[130:131], v[130:131], v[4:5]
    v_cvt_pk_bf16_f32 v56, v128, v129
    v_exp_f32 v130, v130
    v_exp_f32 v131, v131
    v_mfma_f32_32x32x16_bf16 v[224:239], v[32:35], v[48:51], v[224:239]
    v_pk_add_f32 v[132:133], v[132:133], v[4:5]
    v_cvt_pk_bf16_f32 v57, v130, v131
    v_exp_f32 v132, v132
    v_exp_f32 v133, v133
    s_waitcnt lgkmcnt(2)
    s_add_u32 m0, s96, 6144
    s_mov_b32 s48, 516096
    buffer_load_dwordx4 v244, s[44:47], s48 offen lds
    buffer_load_dwordx4 v245, s[44:47], s48 offen offset:1024 lds
    s_waitcnt vmcnt(28)
    ds_read_b64_tr_b16 a[32:33], v240 offset:8192
    ds_read_b64_tr_b16 a[34:35], v240 offset:8704
    ds_read_b64_tr_b16 a[36:37], v241 offset:8192
    ds_read_b64_tr_b16 a[38:39], v241 offset:8704
    v_pk_add_f32 v[134:135], v[134:135], v[4:5]
    v_cvt_pk_bf16_f32 v58, v132, v133
    v_exp_f32 v134, v134
    v_exp_f32 v135, v135
    v_mfma_f32_32x32x16_bf16 v[224:239], v[36:39], v[52:55], v[224:239]
    v_pk_add_f32 v[136:137], v[136:137], v[4:5]
    v_cvt_pk_bf16_f32 v59, v134, v135
    v_exp_f32 v136, v136
    v_exp_f32 v137, v137
    v_pk_add_f32 v[138:139], v[138:139], v[4:5]
    v_cvt_pk_bf16_f32 v60, v136, v137
    v_exp_f32 v138, v138
    v_exp_f32 v139, v139
    s_waitcnt lgkmcnt(0)
    s_add_u32 m0, s96, 8192
    s_mov_b32 s48, 573440
    buffer_load_dwordx4 v244, s[44:47], s48 offen lds
    buffer_load_dwordx4 v245, s[44:47], s48 offen offset:1024 lds
    s_waitcnt vmcnt(28)
    ds_read_b64_tr_b16 a[40:41], v240 offset:10240
    ds_read_b64_tr_b16 a[42:43], v240 offset:10752
    ds_read_b64_tr_b16 a[44:45], v241 offset:10240
    ds_read_b64_tr_b16 a[46:47], v241 offset:10752
    v_pk_add_f32 v[140:141], v[140:141], v[4:5]
    v_cvt_pk_bf16_f32 v61, v138, v139
    v_exp_f32 v140, v140
    v_exp_f32 v141, v141
    v_pk_add_f32 v[142:143], v[142:143], v[4:5]
    v_cvt_pk_bf16_f32 v62, v140, v141
    v_exp_f32 v142, v142
    v_exp_f32 v143, v143
    s_nop 0
    v_cvt_pk_bf16_f32 v63, v142, v143
    ds_read_b128 v[32:35], v7 offset:22528
    ds_read_b128 v[36:39], v7 offset:23552
    v_pk_add_f32 v[144:145], v[144:145], v[4:5]
    v_exp_f32 v144, v144
    v_exp_f32 v145, v145
    v_pk_add_f32 v[146:147], v[146:147], v[4:5]
    v_cvt_pk_bf16_f32 v48, v144, v145
    v_exp_f32 v146, v146
    v_exp_f32 v147, v147
    v_mfma_f32_32x32x16_bf16 v[224:239], v[40:43], v[56:59], v[224:239]
    v_pk_add_f32 v[148:149], v[148:149], v[4:5]
    v_cvt_pk_bf16_f32 v49, v146, v147
    v_exp_f32 v148, v148
    v_exp_f32 v149, v149
    s_waitcnt lgkmcnt(2)
    s_add_u32 m0, s96, 10240
    s_mov_b32 s48, 630784
    buffer_load_dwordx4 v244, s[44:47], s48 offen lds
    buffer_load_dwordx4 v245, s[44:47], s48 offen offset:1024 lds
    s_waitcnt vmcnt(16)
    ds_read_b64_tr_b16 a[48:49], v240 offset:0
    ds_read_b64_tr_b16 a[50:51], v240 offset:512
    ds_read_b64_tr_b16 a[52:53], v241 offset:0
    ds_read_b64_tr_b16 a[54:55], v241 offset:512
    v_pk_add_f32 v[150:151], v[150:151], v[4:5]
    v_cvt_pk_bf16_f32 v50, v148, v149
    v_exp_f32 v150, v150
    v_exp_f32 v151, v151
    v_mfma_f32_32x32x16_bf16 v[224:239], v[44:47], v[60:63], v[224:239]
    v_pk_add_f32 v[152:153], v[152:153], v[4:5]
    v_cvt_pk_bf16_f32 v51, v150, v151
    v_exp_f32 v152, v152
    v_exp_f32 v153, v153
    v_pk_add_f32 v[154:155], v[154:155], v[4:5]
    v_cvt_pk_bf16_f32 v52, v152, v153
    v_exp_f32 v154, v154
    v_exp_f32 v155, v155
    s_waitcnt lgkmcnt(0)
    s_add_u32 m0, s96, 0
    s_mov_b32 s48, 688128
    buffer_load_dwordx4 v244, s[44:47], s48 offen lds
    buffer_load_dwordx4 v245, s[44:47], s48 offen offset:1024 lds
    s_waitcnt vmcnt(12)
    ds_read_b64_tr_b16 a[56:57], v240 offset:2048
    ds_read_b64_tr_b16 a[58:59], v240 offset:2560
    ds_read_b64_tr_b16 a[60:61], v241 offset:2048
    ds_read_b64_tr_b16 a[62:63], v241 offset:2560
    v_pk_add_f32 v[156:157], v[156:157], v[4:5]
    v_cvt_pk_bf16_f32 v53, v154, v155
    v_exp_f32 v156, v156
    v_exp_f32 v157, v157
    v_pk_add_f32 v[158:159], v[158:159], v[4:5]
    v_cvt_pk_bf16_f32 v54, v156, v157
    v_exp_f32 v158, v158
    v_exp_f32 v159, v159
    s_nop 0
    v_cvt_pk_bf16_f32 v55, v158, v159
    ds_read_b128 v[40:43], v7 offset:26624
    ds_read_b128 v[44:47], v7 offset:27648
    v_pk_add_f32 v[160:161], v[160:161], v[4:5]
    v_exp_f32 v160, v160
    v_exp_f32 v161, v161
    v_pk_add_f32 v[162:163], v[162:163], v[4:5]
    v_cvt_pk_bf16_f32 v56, v160, v161
    v_exp_f32 v162, v162
    v_exp_f32 v163, v163
    v_mfma_f32_32x32x16_bf16 v[224:239], v[32:35], v[48:51], v[224:239]
    v_pk_add_f32 v[164:165], v[164:165], v[4:5]
    v_cvt_pk_bf16_f32 v57, v162, v163
    v_exp_f32 v164, v164
    v_exp_f32 v165, v165
    s_waitcnt lgkmcnt(2)
    s_add_u32 m0, s96, 2048
    s_mov_b32 s48, 745472
    buffer_load_dwordx4 v244, s[44:47], s48 offen lds
    buffer_load_dwordx4 v245, s[44:47], s48 offen offset:1024 lds
    s_waitcnt vmcnt(12)
    ds_read_b64_tr_b16 a[64:65], v240 offset:4096
    ds_read_b64_tr_b16 a[66:67], v240 offset:4608
    ds_read_b64_tr_b16 a[68:69], v241 offset:4096
    ds_read_b64_tr_b16 a[70:71], v241 offset:4608
    v_pk_add_f32 v[166:167], v[166:167], v[4:5]
    v_cvt_pk_bf16_f32 v58, v164, v165
    v_exp_f32 v166, v166
    v_exp_f32 v167, v167
    v_mfma_f32_32x32x16_bf16 v[224:239], v[36:39], v[52:55], v[224:239]
    v_pk_add_f32 v[168:169], v[168:169], v[4:5]
    v_cvt_pk_bf16_f32 v59, v166, v167
    v_exp_f32 v168, v168
    v_exp_f32 v169, v169
    v_pk_add_f32 v[170:171], v[170:171], v[4:5]
    v_cvt_pk_bf16_f32 v60, v168, v169
    v_exp_f32 v170, v170
    v_exp_f32 v171, v171
    s_waitcnt lgkmcnt(0)
    s_add_u32 m0, s96, 4096
    s_mov_b32 s48, 802816
    buffer_load_dwordx4 v244, s[44:47], s48 offen lds
    buffer_load_dwordx4 v245, s[44:47], s48 offen offset:1024 lds
    s_waitcnt vmcnt(10)
    ds_read_b64_tr_b16 a[72:73], v240 offset:6144
    ds_read_b64_tr_b16 a[74:75], v240 offset:6656
    ds_read_b64_tr_b16 a[76:77], v241 offset:6144
    ds_read_b64_tr_b16 a[78:79], v241 offset:6656
    v_pk_add_f32 v[172:173], v[172:173], v[4:5]
    v_cvt_pk_bf16_f32 v61, v170, v171
    v_exp_f32 v172, v172
    v_exp_f32 v173, v173
    v_pk_add_f32 v[174:175], v[174:175], v[4:5]
    v_cvt_pk_bf16_f32 v62, v172, v173
    v_exp_f32 v174, v174
    v_exp_f32 v175, v175
    s_nop 0
    v_cvt_pk_bf16_f32 v63, v174, v175
    ds_read_b128 v[32:35], v7 offset:30720
    ds_read_b128 v[36:39], v7 offset:31744
    s_barrier
    v_pk_add_f32 v[176:177], v[176:177], v[4:5]
    v_exp_f32 v176, v176
    v_exp_f32 v177, v177
    v_pk_add_f32 v[178:179], v[178:179], v[4:5]
    v_cvt_pk_bf16_f32 v48, v176, v177
    v_exp_f32 v178, v178
    v_exp_f32 v179, v179
    v_mfma_f32_32x32x16_bf16 v[224:239], v[40:43], v[56:59], v[224:239]
    v_pk_add_f32 v[180:181], v[180:181], v[4:5]
    v_cvt_pk_bf16_f32 v49, v178, v179
    v_exp_f32 v180, v180
    v_exp_f32 v181, v181
    s_waitcnt lgkmcnt(2)
    s_add_u32 m0, s96, 6144
    s_mov_b32 s48, 860160
    buffer_load_dwordx4 v244, s[44:47], s48 offen lds
    buffer_load_dwordx4 v245, s[44:47], s48 offen offset:1024 lds
    s_waitcnt vmcnt(10)
    ds_read_b64_tr_b16 a[80:81], v240 offset:8192
    ds_read_b64_tr_b16 a[82:83], v240 offset:8704
    ds_read_b64_tr_b16 a[84:85], v241 offset:8192
    ds_read_b64_tr_b16 a[86:87], v241 offset:8704
    v_pk_add_f32 v[182:183], v[182:183], v[4:5]
    v_cvt_pk_bf16_f32 v50, v180, v181
    v_exp_f32 v182, v182
    v_exp_f32 v183, v183
    v_mfma_f32_32x32x16_bf16 v[224:239], v[44:47], v[60:63], v[224:239]
    v_pk_add_f32 v[184:185], v[184:185], v[4:5]
    v_cvt_pk_bf16_f32 v51, v182, v183
    v_exp_f32 v184, v184
    v_exp_f32 v185, v185
    v_pk_add_f32 v[186:187], v[186:187], v[4:5]
    v_cvt_pk_bf16_f32 v52, v184, v185
    v_exp_f32 v186, v186
    v_exp_f32 v187, v187
    s_waitcnt lgkmcnt(0)
    s_add_u32 m0, s96, 8192
    s_mov_b32 s48, 917504
    buffer_load_dwordx4 v244, s[44:47], s48 offen lds
    buffer_load_dwordx4 v245, s[44:47], s48 offen offset:1024 lds
    s_waitcnt vmcnt(10)
    ds_read_b64_tr_b16 a[88:89], v240 offset:10240
    ds_read_b64_tr_b16 a[90:91], v240 offset:10752
    ds_read_b64_tr_b16 a[92:93], v241 offset:10240
    ds_read_b64_tr_b16 a[94:95], v241 offset:10752
    v_pk_add_f32 v[188:189], v[188:189], v[4:5]
    v_cvt_pk_bf16_f32 v53, v186, v187
    v_exp_f32 v188, v188
    v_exp_f32 v189, v189
    v_pk_add_f32 v[190:191], v[190:191], v[4:5]
    v_cvt_pk_bf16_f32 v54, v188, v189
    v_exp_f32 v190, v190
    v_exp_f32 v191, v191
    s_nop 0
    v_cvt_pk_bf16_f32 v55, v190, v191
    ds_read_b128 v[40:43], v7 offset:34816
    ds_read_b128 v[44:47], v7 offset:35840
    v_pk_add_f32 v[64:65], v[64:65], v[4:5]
    v_exp_f32 v64, v64
    v_exp_f32 v65, v65
    v_pk_add_f32 v[66:67], v[66:67], v[4:5]
    v_cvt_pk_bf16_f32 v56, v64, v65
    v_exp_f32 v66, v66
    v_exp_f32 v67, v67
    v_mfma_f32_32x32x16_bf16 v[224:239], v[32:35], v[48:51], v[224:239]
    v_pk_add_f32 v[68:69], v[68:69], v[4:5]
    v_cvt_pk_bf16_f32 v57, v66, v67
    v_exp_f32 v68, v68
    v_exp_f32 v69, v69
    s_waitcnt lgkmcnt(2)
    s_add_u32 m0, s96, 10240
    s_mov_b32 s48, 974848
    buffer_load_dwordx4 v244, s[44:47], s48 offen lds
    buffer_load_dwordx4 v245, s[44:47], s48 offen offset:1024 lds
    v_pk_add_f32 v[70:71], v[70:71], v[4:5]
    v_cvt_pk_bf16_f32 v58, v68, v69
    v_exp_f32 v70, v70
    v_exp_f32 v71, v71
    v_mfma_f32_32x32x16_bf16 v[224:239], v[36:39], v[52:55], v[224:239]
    v_pk_add_f32 v[72:73], v[72:73], v[4:5]
    v_cvt_pk_bf16_f32 v59, v70, v71
    v_exp_f32 v72, v72
    v_exp_f32 v73, v73
    v_pk_add_f32 v[74:75], v[74:75], v[4:5]
    v_cvt_pk_bf16_f32 v60, v72, v73
    v_exp_f32 v74, v74
    v_exp_f32 v75, v75
    v_pk_add_f32 v[76:77], v[76:77], v[4:5]
    v_cvt_pk_bf16_f32 v61, v74, v75
    v_exp_f32 v76, v76
    v_exp_f32 v77, v77
    v_pk_add_f32 v[78:79], v[78:79], v[4:5]
    v_cvt_pk_bf16_f32 v62, v76, v77
    v_exp_f32 v78, v78
    v_exp_f32 v79, v79
    s_nop 0
    v_cvt_pk_bf16_f32 v63, v78, v79
    ds_read_b128 v[32:35], v7 offset:2048
    ds_read_b128 v[36:39], v7 offset:3072
    v_and_b32 v48, v216, v56
    v_and_b32 v49, v217, v57
    v_and_b32 v50, v218, v58
    v_and_b32 v51, v219, v59
    v_and_b32 v52, v220, v60
    v_and_b32 v53, v221, v61
    v_and_b32 v54, v222, v62
    v_and_b32 v55, v223, v63
    v_bfi_b32 v56, v216, 0, v56
    v_bfi_b32 v57, v217, 0, v57
    v_bfi_b32 v58, v218, 0, v58
    v_bfi_b32 v59, v219, 0, v59
    v_bfi_b32 v60, v220, 0, v60
    v_bfi_b32 v61, v221, 0, v61
    v_bfi_b32 v62, v222, 0, v62
    v_bfi_b32 v63, v223, 0, v63
    s_waitcnt lgkmcnt(2)
    v_mfma_f32_32x32x16_bf16 v[224:239], v[40:43], v[48:51], v[224:239]
    v_mfma_f32_32x32x16_bf16 v[224:239], v[44:47], v[52:55], v[224:239]
    s_waitcnt lgkmcnt(0)
    v_mfma_f32_32x32x16_bf16 v[224:239], v[32:35], v[56:59], v[224:239]
    v_mfma_f32_32x32x16_bf16 v[224:239], v[36:39], v[60:63], v[224:239]
    s_lshl_b32 s50, s31, 4
    s_add_u32 s50, s50, s29
    s_lshl_b32 s51, s50, 11
    s_add_u32 s51, s51, 6291456
    s_lshl_b32 s50, s50, 7
    s_add_u32 s50, s50, 1179648
    v_cmp_gt_u32 vcc, 32, v1
    s_nop 4
    v_mov_b32 v5, v236
    v_mov_b32 v6, v236
    s_nop 1
    v_permlane32_swap_b32 v5, v6
    v_rcp_f32 v6, v6
    s_nop 0
    v_mul_f32 v224, v6, v224
    v_mul_f32 v225, v6, v225
    v_mul_f32 v226, v6, v226
    v_mul_f32 v227, v6, v227
    v_mul_f32 v228, v6, v228
    v_mul_f32 v229, v6, v229
    v_mul_f32 v230, v6, v230
    v_mul_f32 v231, v6, v231
    v_mul_f32 v232, v6, v232
    v_mul_f32 v233, v6, v233
    v_mul_f32 v234, v6, v234
    v_mul_f32 v235, v6, v235
    v_mul_f32 v236, v6, v236
    v_mul_f32 v237, v6, v237
    v_mul_f32 v238, v6, v238
    v_mul_f32 v239, v6, v239
    v_cvt_pk_bf16_f32 v48, v224, v225
    v_cvt_pk_bf16_f32 v49, v226, v227
    v_cvt_pk_bf16_f32 v50, v228, v229
    v_cvt_pk_bf16_f32 v51, v230, v231
    v_cvt_pk_bf16_f32 v52, v232, v233
    v_cvt_pk_bf16_f32 v53, v234, v235
    v_cvt_pk_bf16_f32 v54, v236, v237
    v_cvt_pk_bf16_f32 v55, v238, v239
    v_cndmask_b32 v54, 0, v54, vcc
    v_cndmask_b32 v55, 0, v55, vcc
    s_cmp_eq_u32 s11, 1
    s_cbranch_scc1 sequential_preLN__sliding_block__mixer_token_mlp__prompt_kernel_pl28
    buffer_store_dwordx4 v[48:51], v2, s[32:35], s51 offen sc1
    buffer_store_dwordx4 v[52:55], v2, s[32:35], s51 offen offset:1024 sc1
    s_branch sequential_preLN__sliding_block__mixer_token_mlp__prompt_kernel_pj29
sequential_preLN__sliding_block__mixer_token_mlp__prompt_kernel_pl28:
    buffer_store_dwordx4 v[48:51], v2, s[32:35], s51 offen
    buffer_store_dwordx4 v[52:55], v2, s[32:35], s51 offen offset:1024
sequential_preLN__sliding_block__mixer_token_mlp__prompt_kernel_pj29:
    s_waitcnt vmcnt(12)
    ds_read_b64_tr_b16 a[96:97], v240 offset:0
    ds_read_b64_tr_b16 a[98:99], v240 offset:512
    ds_read_b64_tr_b16 a[100:101], v241 offset:0
    ds_read_b64_tr_b16 a[102:103], v241 offset:512
    s_waitcnt vmcnt(10)
    ds_read_b64_tr_b16 a[104:105], v240 offset:2048
    ds_read_b64_tr_b16 a[106:107], v240 offset:2560
    ds_read_b64_tr_b16 a[108:109], v241 offset:2048
    ds_read_b64_tr_b16 a[110:111], v241 offset:2560
    s_waitcnt vmcnt(8)
    ds_read_b64_tr_b16 a[112:113], v240 offset:4096
    ds_read_b64_tr_b16 a[114:115], v240 offset:4608
    ds_read_b64_tr_b16 a[116:117], v241 offset:4096
    ds_read_b64_tr_b16 a[118:119], v241 offset:4608
    s_waitcnt vmcnt(6)
    ds_read_b64_tr_b16 a[120:121], v240 offset:6144
    ds_read_b64_tr_b16 a[122:123], v240 offset:6656
    ds_read_b64_tr_b16 a[124:125], v241 offset:6144
    ds_read_b64_tr_b16 a[126:127], v241 offset:6656
    s_waitcnt vmcnt(4)
    ds_read_b64_tr_b16 a[128:129], v240 offset:8192
    ds_read_b64_tr_b16 a[130:131], v240 offset:8704
    ds_read_b64_tr_b16 a[132:133], v241 offset:8192
    ds_read_b64_tr_b16 a[134:135], v241 offset:8704
    s_waitcnt vmcnt(2)
    ds_read_b64_tr_b16 a[136:137], v240 offset:10240
    ds_read_b64_tr_b16 a[138:139], v240 offset:10752
    ds_read_b64_tr_b16 a[140:141], v241 offset:10240
    ds_read_b64_tr_b16 a[142:143], v241 offset:10752
    s_lshl_b32 s52, s55, 15
    v_lshrrev_b32 v3, 5, v1
    v_bfe_u32 v4, v1, 2, 2
    v_lshl_add_u32 v4, v3, 2, v4
    v_lshlrev_b32 v4, 7, v4
    v_bfe_u32 v5, v1, 4, 1
    v_lshl_add_u32 v4, v5, 5, v4
    v_and_b32 v5, 3, v1
    v_lshl_add_u32 v4, v5, 3, v4
    v_add_u32 v4, s52, v4
    v_bfe_u32 v5, v1, 3, 1
    v_xor_b32 v5, s55, v5
    v_lshl_add_u32 v100, v5, 6, v4
    v_xor_b32 v5, 1, v5
    v_lshl_add_u32 v101, v5, 6, v4
    ds_read_b64_tr_b16 v[112:113], v100 offset:0
    ds_read_b64_tr_b16 v[114:115], v100 offset:1024
    ds_read_b64_tr_b16 v[116:117], v101 offset:0
    ds_read_b64_tr_b16 v[118:119], v101 offset:1024
    ds_read_b64_tr_b16 v[120:121], v100 offset:2048
    ds_read_b64_tr_b16 v[122:123], v100 offset:3072
    ds_read_b64_tr_b16 v[124:125], v101 offset:2048
    ds_read_b64_tr_b16 v[126:127], v101 offset:3072
    ds_read_b64_tr_b16 v[128:129], v100 offset:4096
    ds_read_b64_tr_b16 v[130:131], v100 offset:5120
    ds_read_b64_tr_b16 v[132:133], v101 offset:4096
    ds_read_b64_tr_b16 v[134:135], v101 offset:5120
    ds_read_b64_tr_b16 v[136:137], v100 offset:6144
    ds_read_b64_tr_b16 v[138:139], v100 offset:7168
    ds_read_b64_tr_b16 v[140:141], v101 offset:6144
    ds_read_b64_tr_b16 v[142:143], v101 offset:7168
    ds_read_b64_tr_b16 v[144:145], v100 offset:8192
    ds_read_b64_tr_b16 v[146:147], v100 offset:9216
    ds_read_b64_tr_b16 v[148:149], v101 offset:8192
    ds_read_b64_tr_b16 v[150:151], v101 offset:9216
    ds_read_b64_tr_b16 v[152:153], v100 offset:10240
    ds_read_b64_tr_b16 v[154:155], v100 offset:11264
    ds_read_b64_tr_b16 v[156:157], v101 offset:10240
    ds_read_b64_tr_b16 v[158:159], v101 offset:11264
    s_waitcnt vmcnt(0)
    v_mov_b32 v3, s26
    v_mov_b32 v4, 0
    s_mov_b64 exec, 1
    s_cmp_eq_u32 s11, 1
    s_cbranch_scc1 sequential_preLN__sliding_block__mixer_token_mlp__prompt_kernel_pl30
    buffer_store_dword v3, v4, s[32:35], s50 offen sc1
    s_branch sequential_preLN__sliding_block__mixer_token_mlp__prompt_kernel_pj31
sequential_preLN__sliding_block__mixer_token_mlp__prompt_kernel_pl30:
    buffer_store_dword v3, v4, s[32:35], s50 offen
sequential_preLN__sliding_block__mixer_token_mlp__prompt_kernel_pj31:
    s_mov_b64 exec, -1
    ds_read_b64_tr_b16 v[160:161], v100 offset:12288
    ds_read_b64_tr_b16 v[162:163], v100 offset:13312
    ds_read_b64_tr_b16 v[164:165], v101 offset:12288
    ds_read_b64_tr_b16 v[166:167], v101 offset:13312
    ds_read_b64_tr_b16 v[168:169], v100 offset:14336
    ds_read_b64_tr_b16 v[170:171], v100 offset:15360
    ds_read_b64_tr_b16 v[172:173], v101 offset:14336
    ds_read_b64_tr_b16 v[174:175], v101 offset:15360
    ds_read_b64_tr_b16 v[176:177], v100 offset:16384
    ds_read_b64_tr_b16 v[178:179], v100 offset:17408
    ds_read_b64_tr_b16 v[180:181], v101 offset:16384
    ds_read_b64_tr_b16 v[182:183], v101 offset:17408
    ds_read_b64_tr_b16 v[184:185], v100 offset:18432
    ds_read_b64_tr_b16 v[186:187], v100 offset:19456
    ds_read_b64_tr_b16 v[188:189], v101 offset:18432
    ds_read_b64_tr_b16 v[190:191], v101 offset:19456
    ds_read_b64_tr_b16 v[192:193], v100 offset:20480
    ds_read_b64_tr_b16 v[194:195], v100 offset:21504
    ds_read_b64_tr_b16 v[196:197], v101 offset:20480
    ds_read_b64_tr_b16 v[198:199], v101 offset:21504
    ds_read_b64_tr_b16 v[200:201], v100 offset:22528
    ds_read_b64_tr_b16 v[202:203], v100 offset:23552
    ds_read_b64_tr_b16 v[204:205], v101 offset:22528
    ds_read_b64_tr_b16 v[206:207], v101 offset:23552
    ds_read_b64_tr_b16 v[208:209], v100 offset:24576
    ds_read_b64_tr_b16 v[210:211], v100 offset:25600
    ds_read_b64_tr_b16 v[212:213], v101 offset:24576
    ds_read_b64_tr_b16 v[214:215], v101 offset:25600
    ds_read_b64_tr_b16 v[216:217], v100 offset:26624
    ds_read_b64_tr_b16 v[218:219], v100 offset:27648
    ds_read_b64_tr_b16 v[220:221], v101 offset:26624
    ds_read_b64_tr_b16 v[222:223], v101 offset:27648
    ds_read_b64_tr_b16 v[224:225], v100 offset:28672
    ds_read_b64_tr_b16 v[226:227], v100 offset:29696
    ds_read_b64_tr_b16 v[228:229], v101 offset:28672
    ds_read_b64_tr_b16 v[230:231], v101 offset:29696
    ds_read_b64_tr_b16 v[232:233], v100 offset:30720
    ds_read_b64_tr_b16 v[234:235], v100 offset:31744
    ds_read_b64_tr_b16 v[236:237], v101 offset:30720
    ds_read_b64_tr_b16 v[238:239], v101 offset:31744
    s_lshr_b32 s56, s3, 1
    s_lshl_b32 s64, s61, 1
    s_add_u32 s64, s64, s56
    s_lshl_b32 s65, s60, 1
    s_add_u32 s65, s65, s55
    v_and_b32 v6, 31, v1
    v_lshrrev_b32 v7, 5, v1
    s_lshl_b32 s51, s64, 15
    s_lshl_b32 s52, s55, 14
    s_add_u32 s51, s51, s52
    s_add_u32 s51, s51, 6291456
    s_lshl_b32 s66, s64, 11
    s_lshl_b32 s52, s55, 10
    s_add_u32 s66, s66, s52
    s_add_u32 s66, s66, 1179648
    s_add_u32 s40, s24, s51
    s_addc_u32 s41, s25, 0
    s_mov_b32 s42, 16384
    s_mov_b32 s43, 0x20000
    s_waitcnt lgkmcnt(0)
    s_barrier
    s_cmp_ge_u32 s28, 28
    s_cbranch_scc1 sequential_preLN__sliding_block__mixer_token_mlp__prompt_kernel_nonC1
    v_permlane32_swap_b32 v8, v10
    v_permlane32_swap_b32 v9, v11
    v_permlane32_swap_b32 v12, v14
    v_permlane32_swap_b32 v13, v15
    v_and_b32 v4, 7, v1
    v_lshlrev_b32 v4, 7, v4
    s_mov_b32 s98, 0
    s_mov_b32 s58, 0xff
    s_mov_b32 s59, 0
sequential_preLN__sliding_block__mixer_token_mlp__prompt_kernel_poll32:
    s_mov_b64 exec, s[58:59]
    buffer_load_dword v3, v4, s[32:35], s66 offen sc1
    s_waitcnt vmcnt(0)
    v_cmp_ne_u32 s[58:59], s26, v3
    s_ff1_i32_b32 s99, s58
    s_cmp_lt_i32 s99, 0
    s_cbranch_scc1 sequential_preLN__sliding_block__mixer_token_mlp__prompt_kernel_got34
    s_lshl_b64 exec, 1, s99
    s_andn2_b64 s[58:59], s[58:59], exec
sequential_preLN__sliding_block__mixer_token_mlp__prompt_kernel_one33:
    buffer_load_dword v3, v4, s[32:35], s66 offen sc1
    s_add_u32 s98, s98, 1
    s_waitcnt vmcnt(0)
    v_cmp_ne_u32 vcc, s26, v3
    s_cmp_gt_u32 s98, 30000
    s_cbranch_scc1 sequential_preLN__sliding_block__mixer_token_mlp__prompt_kernel_got34
    s_cbranch_vccnz sequential_preLN__sliding_block__mixer_token_mlp__prompt_kernel_one33
    s_cmp_lg_u32 s58, 0
    s_cbranch_scc1 sequential_preLN__sliding_block__mixer_token_mlp__prompt_kernel_poll32
sequential_preLN__sliding_block__mixer_token_mlp__prompt_kernel_got34:
    s_mov_b64 exec, -1
    s_movk_i32 s48, 0
    buffer_load_dwordx4 v[48:51], v2, s[40:43], s48 offen offset:0 sc1
    buffer_load_dwordx4 v[52:55], v2, s[40:43], s48 offen offset:1024 sc1
    buffer_load_dwordx4 v[56:59], v2, s[40:43], s48 offen offset:2048 sc1
    buffer_load_dwordx4 v[60:63], v2, s[40:43], s48 offen offset:3072 sc1
    s_movk_i32 s48, 4096
    buffer_load_dwordx4 v[64:67], v2, s[40:43], s48 offen offset:0 sc1
    buffer_load_dwordx4 v[68:71], v2, s[40:43], s48 offen offset:1024 sc1
    buffer_load_dwordx4 v[72:75], v2, s[40:43], s48 offen offset:2048 sc1
    buffer_load_dwordx4 v[76:79], v2, s[40:43], s48 offen offset:3072 sc1
    s_movk_i32 s48, 8192
    buffer_load_dwordx4 v[80:83], v2, s[40:43], s48 offen offset:0 sc1
    buffer_load_dwordx4 v[84:87], v2, s[40:43], s48 offen offset:1024 sc1
    buffer_load_dwordx4 v[88:91], v2, s[40:43], s48 offen offset:2048 sc1
    buffer_load_dwordx4 v[92:95], v2, s[40:43], s48 offen offset:3072 sc1
    s_movk_i32 s48, 12288
    buffer_load_dwordx4 v[96:99], v2, s[40:43], s48 offen offset:0 sc1
    buffer_load_dwordx4 v[100:103], v2, s[40:43], s48 offen offset:1024 sc1
    buffer_load_dwordx4 v[104:107], v2, s[40:43], s48 offen offset:2048 sc1
    buffer_load_dwordx4 v[108:111], v2, s[40:43], s48 offen offset:3072 sc1
    s_mul_i32 s50, s64, 7168
    s_add_u32 s50, s50, 14680064
    s_lshl_b32 s51, s65, 9
    s_add_u32 s51, s51, s50
    s_xor_b32 s52, s3, 1
    s_lshl_b32 s52, s52, 12
    s_add_u32 s52, s52, 65536
    s_lshl_b32 s53, s3, 12
    s_add_u32 s53, s53, 65536
    s_waitcnt vmcnt(15)
    v_mfma_f32_32x32x16_bf16 v[16:31], v[112:115], v[48:51], 0
    v_mfma_f32_32x32x16_bf16 v[32:47], v[116:119], v[48:51], 0
    s_waitcnt vmcnt(14)
    v_mfma_f32_32x32x16_bf16 v[16:31], v[120:123], v[52:55], v[16:31]
    v_mfma_f32_32x32x16_bf16 v[32:47], v[124:127], v[52:55], v[32:47]
    s_waitcnt vmcnt(13)
    v_mfma_f32_32x32x16_bf16 v[16:31], v[128:131], v[56:59], v[16:31]
    v_mfma_f32_32x32x16_bf16 v[32:47], v[132:135], v[56:59], v[32:47]
    s_waitcnt vmcnt(12)
    v_mfma_f32_32x32x16_bf16 v[16:31], v[136:139], v[60:63], v[16:31]
    v_mfma_f32_32x32x16_bf16 v[32:47], v[140:143], v[60:63], v[32:47]
    s_waitcnt vmcnt(11)
    v_mfma_f32_32x32x16_bf16 v[16:31], v[144:147], v[64:67], v[16:31]
    v_mfma_f32_32x32x16_bf16 v[32:47], v[148:151], v[64:67], v[32:47]
    s_waitcnt vmcnt(10)
    v_mfma_f32_32x32x16_bf16 v[16:31], v[152:155], v[68:71], v[16:31]
    v_mfma_f32_32x32x16_bf16 v[32:47], v[156:159], v[68:71], v[32:47]
    s_waitcnt vmcnt(9)
    v_mfma_f32_32x32x16_bf16 v[16:31], v[160:163], v[72:75], v[16:31]
    v_mfma_f32_32x32x16_bf16 v[32:47], v[164:167], v[72:75], v[32:47]
    s_waitcnt vmcnt(8)
    v_mfma_f32_32x32x16_bf16 v[16:31], v[168:171], v[76:79], v[16:31]
    v_mfma_f32_32x32x16_bf16 v[32:47], v[172:175], v[76:79], v[32:47]
    s_waitcnt vmcnt(7)
    v_mfma_f32_32x32x16_bf16 v[16:31], v[176:179], v[80:83], v[16:31]
    v_mfma_f32_32x32x16_bf16 v[32:47], v[180:183], v[80:83], v[32:47]
    s_waitcnt vmcnt(6)
    v_mfma_f32_32x32x16_bf16 v[16:31], v[184:187], v[84:87], v[16:31]
    v_mfma_f32_32x32x16_bf16 v[32:47], v[188:191], v[84:87], v[32:47]
    s_waitcnt vmcnt(5)
    v_mfma_f32_32x32x16_bf16 v[16:31], v[192:195], v[88:91], v[16:31]
    v_mfma_f32_32x32x16_bf16 v[32:47], v[196:199], v[88:91], v[32:47]
    s_add_u32 m0, s97, 0
    s_mov_b32 s48, 1032192
    buffer_load_dwordx4 v244, s[44:47], s48 offen lds
    buffer_load_dwordx4 v245, s[44:47], s48 offen offset:1024 lds
    s_waitcnt vmcnt(6)
    v_mfma_f32_32x32x16_bf16 v[16:31], v[200:203], v[92:95], v[16:31]
    v_mfma_f32_32x32x16_bf16 v[32:47], v[204:207], v[92:95], v[32:47]
    s_add_u32 m0, s97, 2048
    s_mov_b32 s48, 1089536
    buffer_load_dwordx4 v244, s[44:47], s48 offen lds
    buffer_load_dwordx4 v245, s[44:47], s48 offen offset:1024 lds
    s_waitcnt vmcnt(7)
    v_mfma_f32_32x32x16_bf16 v[16:31], v[208:211], v[96:99], v[16:31]
    v_mfma_f32_32x32x16_bf16 v[32:47], v[212:215], v[96:99], v[32:47]
    s_add_u32 m0, s97, 4096
    s_mov_b32 s48, 1146880
    buffer_load_dwordx4 v244, s[44:47], s48 offen lds
    buffer_load_dwordx4 v245, s[44:47], s48 offen offset:1024 lds
    s_waitcnt vmcnt(8)
    v_mfma_f32_32x32x16_bf16 v[16:31], v[216:219], v[100:103], v[16:31]
    v_mfma_f32_32x32x16_bf16 v[32:47], v[220:223], v[100:103], v[32:47]
    s_add_u32 m0, s97, 6144
    s_mov_b32 s48, 1204224
    buffer_load_dwordx4 v244, s[44:47], s48 offen lds
    buffer_load_dwordx4 v245, s[44:47], s48 offen offset:1024 lds
    s_waitcnt vmcnt(9)
    v_mfma_f32_32x32x16_bf16 v[16:31], v[224:227], v[104:107], v[16:31]
    v_mfma_f32_32x32x16_bf16 v[32:47], v[228:231], v[104:107], v[32:47]
    s_add_u32 m0, s97, 8192
    s_mov_b32 s48, 1261568
    buffer_load_dwordx4 v244, s[44:47], s48 offen lds
    buffer_load_dwordx4 v245, s[44:47], s48 offen offset:1024 lds
    s_waitcnt vmcnt(10)
    v_mfma_f32_32x32x16_bf16 v[16:31], v[232:235], v[108:111], v[16:31]
    v_mfma_f32_32x32x16_bf16 v[32:47], v[236:239], v[108:111], v[32:47]
    s_add_u32 m0, s97, 10240
    s_mov_b32 s48, 1318912
    buffer_load_dwordx4 v244, s[44:47], s48 offen lds
    buffer_load_dwordx4 v245, s[44:47], s48 offen offset:1024 lds
    v_add_u32 v3, s52, v2
    v_add_u32 v4, s53, v2
    s_nop 5
    ds_write_b128 v3, v[32:35] offset:0
    ds_write_b128 v3, v[36:39] offset:1024
    ds_write_b128 v3, v[40:43] offset:2048
    ds_write_b128 v3, v[44:47] offset:3072
    v_lshlrev_b32 v5, 16, v8
    v_and_b32 v6, 0xffff0000, v8
    v_add_f32 v16, v16, v5
    v_add_f32 v17, v17, v6
    v_lshlrev_b32 v5, 16, v9
    v_and_b32 v6, 0xffff0000, v9
    v_add_f32 v18, v18, v5
    v_add_f32 v19, v19, v6
    s_add_u32 m0, s97, 12288
    s_mov_b32 s48, 1376256
    buffer_load_dwordx4 v244, s[44:47], s48 offen lds
    buffer_load_dwordx4 v245, s[44:47], s48 offen offset:1024 lds
    v_lshlrev_b32 v5, 16, v10
    v_and_b32 v6, 0xffff0000, v10
    v_add_f32 v20, v20, v5
    v_add_f32 v21, v21, v6
    v_lshlrev_b32 v5, 16, v11
    v_and_b32 v6, 0xffff0000, v11
    v_add_f32 v22, v22, v5
    v_add_f32 v23, v23, v6
    s_add_u32 m0, s97, 14336
    s_mov_b32 s48, 1433600
    buffer_load_dwordx4 v244, s[44:47], s48 offen lds
    buffer_load_dwordx4 v245, s[44:47], s48 offen offset:1024 lds
    v_lshlrev_b32 v5, 16, v12
    v_and_b32 v6, 0xffff0000, v12
    v_add_f32 v24, v24, v5
    v_add_f32 v25, v25, v6
    v_lshlrev_b32 v5, 16, v13
    v_and_b32 v6, 0xffff0000, v13
    v_add_f32 v26, v26, v5
    v_add_f32 v27, v27, v6
    v_lshlrev_b32 v5, 16, v14
    v_and_b32 v6, 0xffff0000, v14
    v_add_f32 v28, v28, v5
    v_add_f32 v29, v29, v6
    v_lshlrev_b32 v5, 16, v15
    v_and_b32 v6, 0xffff0000, v15
    v_add_f32 v30, v30, v5
    v_add_f32 v31, v31, v6
    s_waitcnt lgkmcnt(0)
    s_barrier
    ds_read_b128 v[32:35], v4 offset:0
    ds_read_b128 v[36:39], v4 offset:1024
    ds_read_b128 v[40:43], v4 offset:2048
    ds_read_b128 v[44:47], v4 offset:3072
    v_and_b32 v3, 31, v1
    v_lshrrev_b32 v4, 5, v1
    v_lshlrev_b32 v12, 4, v3
    v_lshl_add_u32 v13, v4, 9, v12
    s_lshl_b32 s52, s3, 11
    s_add_u32 s52, s52, 81920
    v_lshlrev_b32 v14, 6, v3
    v_lshl_add_u32 v14, v4, 3, v14
    v_add_u32 v14, s52, v14
    v_bfe_u32 v5, v1, 2, 2
    v_lshl_add_u32 v5, v4, 3, v5
    v_lshlrev_b32 v5, 6, v5
    v_bfe_u32 v6, v1, 4, 1
    v_lshl_add_u32 v5, v6, 5, v5
    v_and_b32 v6, 3, v1
    v_lshl_add_u32 v5, v6, 3, v5
    v_add_u32 v15, s52, v5
    s_waitcnt lgkmcnt(3)
    v_pk_add_f32 v[16:17], v[16:17], v[32:33]
    v_pk_add_f32 v[18:19], v[18:19], v[34:35]
    s_waitcnt lgkmcnt(2)
    v_pk_add_f32 v[20:21], v[20:21], v[36:37]
    v_pk_add_f32 v[22:23], v[22:23], v[38:39]
    s_waitcnt lgkmcnt(1)
    v_pk_add_f32 v[24:25], v[24:25], v[40:41]
    v_pk_add_f32 v[26:27], v[26:27], v[42:43]
    s_waitcnt lgkmcnt(0)
    v_pk_add_f32 v[28:29], v[28:29], v[44:45]
    v_pk_add_f32 v[30:31], v[30:31], v[46:47]
    v_pk_add_f32 v[4:5], v[16:17], v[18:19]
    v_pk_mul_f32 v[6:7], v[16:17], v[16:17]
    v_pk_fma_f32 v[6:7], v[18:19], v[18:19], v[6:7]
    v_pk_add_f32 v[4:5], v[4:5], v[20:21]
    v_pk_fma_f32 v[6:7], v[20:21], v[20:21], v[6:7]
    v_pk_add_f32 v[4:5], v[4:5], v[22:23]
    v_pk_fma_f32 v[6:7], v[22:23], v[22:23], v[6:7]
    v_pk_add_f32 v[4:5], v[4:5], v[24:25]
    v_pk_fma_f32 v[6:7], v[24:25], v[24:25], v[6:7]
    v_pk_add_f32 v[4:5], v[4:5], v[26:27]
    v_pk_fma_f32 v[6:7], v[26:27], v[26:27], v[6:7]
    v_pk_add_f32 v[4:5], v[4:5], v[28:29]
    v_pk_fma_f32 v[6:7], v[28:29], v[28:29], v[6:7]
    v_pk_add_f32 v[4:5], v[4:5], v[30:31]
    v_pk_fma_f32 v[6:7], v[30:31], v[30:31], v[6:7]
    v_add_f32 v4, v4, v5
    v_add_f32 v5, v6, v7
    v_mov_b32 v6, v4
    v_mov_b32 v7, v5
    s_nop 0
    v_permlane32_swap_b32 v4, v6
    v_permlane32_swap_b32 v5, v7
    v_add_f32 v4, v4, v6
    v_add_f32 v5, v5, v7
    v_mov_b32 v6, s26
    v_mov_b32 v7, s26
    s_mov_b64 exec, 0xffffffff
    s_cmp_eq_u32 s11, 1
    s_cbranch_scc1 sequential_preLN__sliding_block__mixer_token_mlp__prompt_kernel_pl35
    buffer_store_dwordx4 v[4:7], v12, s[32:35], s51 offen sc1
    s_branch sequential_preLN__sliding_block__mixer_token_mlp__prompt_kernel_pj36
sequential_preLN__sliding_block__mixer_token_mlp__prompt_kernel_pl35:
    buffer_store_dwordx4 v[4:7], v12, s[32:35], s51 offen
sequential_preLN__sliding_block__mixer_token_mlp__prompt_kernel_pj36:
    s_mov_b64 exec, -1
    v_cvt_pk_bf16_f32 v48, v16, v17
    v_cvt_pk_bf16_f32 v49, v18, v19
    v_cvt_pk_bf16_f32 v50, v20, v21
    v_cvt_pk_bf16_f32 v51, v22, v23
    v_cvt_pk_bf16_f32 v52, v24, v25
    v_cvt_pk_bf16_f32 v53, v26, v27
    v_cvt_pk_bf16_f32 v54, v28, v29
    v_cvt_pk_bf16_f32 v55, v30, v31
    s_mul_i32 s52, s64, 14
    s_add_u32 s52, s52, s65
    s_lshl_b32 s52, s52, 11
    s_add_u32 s52, s52, 8388608
    s_waitcnt vmcnt(15)
    ds_read_b64_tr_b16 a[144:145], v242 offset:0
    ds_read_b64_tr_b16 a[146:147], v242 offset:512
    ds_read_b64_tr_b16 a[148:149], v243 offset:0
    ds_read_b64_tr_b16 a[150:151], v243 offset:512
    s_waitcnt vmcnt(13)
    ds_read_b64_tr_b16 a[152:153], v242 offset:2048
    ds_read_b64_tr_b16 a[154:155], v242 offset:2560
    ds_read_b64_tr_b16 a[156:157], v243 offset:2048
    ds_read_b64_tr_b16 a[158:159], v243 offset:2560
    s_waitcnt vmcnt(11)
    ds_read_b64_tr_b16 a[160:161], v242 offset:4096
    ds_read_b64_tr_b16 a[162:163], v242 offset:4608
    ds_read_b64_tr_b16 a[164:165], v243 offset:4096
    ds_read_b64_tr_b16 a[166:167], v243 offset:4608
    s_waitcnt vmcnt(9)
    ds_read_b64_tr_b16 a[168:169], v242 offset:6144
    ds_read_b64_tr_b16 a[170:171], v242 offset:6656
    ds_read_b64_tr_b16 a[172:173], v243 offset:6144
    ds_read_b64_tr_b16 a[174:175], v243 offset:6656
    s_waitcnt vmcnt(7)
    ds_read_b64_tr_b16 a[176:177], v242 offset:8192
    ds_read_b64_tr_b16 a[178:179], v242 offset:8704
    ds_read_b64_tr_b16 a[180:181], v243 offset:8192
    ds_read_b64_tr_b16 a[182:183], v243 offset:8704
    s_waitcnt vmcnt(5)
    ds_read_b64_tr_b16 a[184:185], v242 offset:10240
    ds_read_b64_tr_b16 a[186:187], v242 offset:10752
    ds_read_b64_tr_b16 a[188:189], v243 offset:10240
    ds_read_b64_tr_b16 a[190:191], v243 offset:10752
    s_waitcnt vmcnt(3)
    ds_read_b64_tr_b16 a[192:193], v242 offset:12288
    ds_read_b64_tr_b16 a[194:195], v242 offset:12800
    ds_read_b64_tr_b16 a[196:197], v243 offset:12288
    ds_read_b64_tr_b16 a[198:199], v243 offset:12800
    s_waitcnt vmcnt(1)
    ds_read_b64_tr_b16 a[200:201], v242 offset:14336
    ds_read_b64_tr_b16 a[202:203], v242 offset:14848
    ds_read_b64_tr_b16 a[204:205], v243 offset:14336
    ds_read_b64_tr_b16 a[206:207], v243 offset:14848
    s_add_u32 s53, s50, 4096
    s_mov_b32 s98, 0
sequential_preLN__sliding_block__mixer_token_mlp__prompt_kernel_xpoll37:
    buffer_load_dwordx4 v[64:67], v13, s[32:35], s50 offen offset:0 sc1
    buffer_load_dwordx4 v[68:71], v13, s[32:35], s50 offen offset:1024 sc1
    buffer_load_dwordx4 v[72:75], v13, s[32:35], s50 offen offset:2048 sc1
    buffer_load_dwordx4 v[76:79], v13, s[32:35], s50 offen offset:3072 sc1
    buffer_load_dwordx4 v[80:83], v13, s[32:35], s53 offen offset:0 sc1
    buffer_load_dwordx4 v[84:87], v13, s[32:35], s53 offen offset:1024 sc1
    buffer_load_dwordx4 v[88:91], v13, s[32:35], s53 offen offset:2048 sc1
    v_mov_b32 v4, -1
    s_waitcnt vmcnt(6)
    v_cmp_ne_u32 vcc, s26, v66
    s_nop 1
    v_cndmask_b32 v4, v4, 0, vcc
    s_waitcnt vmcnt(5)
    v_cmp_ne_u32 vcc, s26, v70
    s_nop 1
    v_cndmask_b32 v4, v4, 1, vcc
    s_waitcnt vmcnt(4)
    v_cmp_ne_u32 vcc, s26, v74
    s_nop 1
    v_cndmask_b32 v4, v4, 2, vcc
    s_waitcnt vmcnt(3)
    v_cmp_ne_u32 vcc, s26, v78
    s_nop 1
    v_cndmask_b32 v4, v4, 3, vcc
    s_waitcnt vmcnt(2)
    v_cmp_ne_u32 vcc, s26, v82
    s_nop 1
    v_cndmask_b32 v4, v4, 4, vcc
    s_waitcnt vmcnt(1)
    v_cmp_ne_u32 vcc, s26, v86
    s_nop 1
    v_cndmask_b32 v4, v4, 5, vcc
    s_waitcnt vmcnt(0)
    v_cmp_ne_u32 vcc, s26, v90
    s_nop 1
    v_cndmask_b32 v4, v4, 6, vcc
    v_cmp_le_i32 s[58:59], 0, v4
    v_lshl_add_u32 v4, v4, 10, v13
    s_ff1_i32_b64 s99, s[58:59]
    s_cmp_lt_i32 s99, 0
    s_cbranch_scc1 sequential_preLN__sliding_block__mixer_token_mlp__prompt_kernel_xgot39
    s_lshl_b64 exec, 1, s99
sequential_preLN__sliding_block__mixer_token_mlp__prompt_kernel_xone38:
    buffer_load_dword v3, v4, s[32:35], s50 offen offset:8 sc1
    s_add_u32 s98, s98, 1
    s_waitcnt vmcnt(0)
    v_cmp_ne_u32 vcc, s26, v3
    s_cmp_gt_u32 s98, 30000
    s_cbranch_scc1 sequential_preLN__sliding_block__mixer_token_mlp__prompt_kernel_xgot39
    s_cbranch_vccnz sequential_preLN__sliding_block__mixer_token_mlp__prompt_kernel_xone38
    s_mov_b64 exec, -1
    s_branch sequential_preLN__sliding_block__mixer_token_mlp__prompt_kernel_xpoll37
sequential_preLN__sliding_block__mixer_token_mlp__prompt_kernel_xgot39:
    s_mov_b64 exec, -1
    buffer_store_dwordx4 v[48:51], v2, s[32:35], s52 offen sc1
    buffer_store_dwordx4 v[52:55], v2, s[32:35], s52 offen offset:1024 sc1
    v_pk_add_f32 v[64:65], v[64:65], v[68:69]
    v_pk_add_f32 v[64:65], v[64:65], v[72:73]
    v_pk_add_f32 v[64:65], v[64:65], v[76:77]
    v_pk_add_f32 v[64:65], v[64:65], v[80:81]
    v_pk_add_f32 v[64:65], v[64:65], v[84:85]
    v_pk_add_f32 v[64:65], v[64:65], v[88:89]
    v_mov_b32 v6, v64
    v_mov_b32 v7, v65
    s_nop 0
    v_permlane32_swap_b32 v64, v6
    v_permlane32_swap_b32 v65, v7
    v_add_f32 v4, v64, v6
    v_add_f32 v5, v65, v7
    v_mul_f32 v4, 0x3b124925, v4
    v_mul_f32 v5, 0x3b124925, v5
    v_fma_f32 v5, -v4, v4, v5
    v_max_f32 v5, 0, v5
    v_add_f32 v6, 0x3727c5ac, v5
    v_rsq_f32 v6, v6
    s_nop 0
    v_mul_f32 v5, v5, v6
    v_mul_f32 v5, v5, v6
    v_add_f32 v5, 0x3727c5ac, v5
    v_rsq_f32 v5, v5
    s_nop 0
    v_mul_f32 v5, v5, v6
    v_mul_f32 v4, v4, v5
    v_fma_f32 v16, v16, v5, -v4
    v_fma_f32 v17, v17, v5, -v4
    v_fma_f32 v18, v18, v5, -v4
    v_fma_f32 v19, v19, v5, -v4
    v_fma_f32 v20, v20, v5, -v4
    v_fma_f32 v21, v21, v5, -v4
    v_fma_f32 v22, v22, v5, -v4
    v_fma_f32 v23, v23, v5, -v4
    v_fma_f32 v24, v24, v5, -v4
    v_fma_f32 v25, v25, v5, -v4
    v_fma_f32 v26, v26, v5, -v4
    v_fma_f32 v27, v27, v5, -v4
    v_fma_f32 v28, v28, v5, -v4
    v_fma_f32 v29, v29, v5, -v4
    v_fma_f32 v30, v30, v5, -v4
    v_fma_f32 v31, v31, v5, -v4
    v_cvt_pk_bf16_f32 v56, v16, v17
    v_cvt_pk_bf16_f32 v57, v18, v19
    v_cvt_pk_bf16_f32 v58, v20, v21
    v_cvt_pk_bf16_f32 v59, v22, v23
    v_cvt_pk_bf16_f32 v60, v24, v25
    v_cvt_pk_bf16_f32 v61, v26, v27
    v_cvt_pk_bf16_f32 v62, v28, v29
    v_cvt_pk_bf16_f32 v63, v30, v31
    ds_write_b64 v14, v[56:57] offset:0
    ds_write_b64 v14, v[58:59] offset:16
    ds_write_b64 v14, v[60:61] offset:32
    ds_write_b64 v14, v[62:63] offset:48
    s_lshl_b32 s52, s65, 7
    s_lshl_b32 s53, s64, 1
    s_add_u32 s52, s52, s53
    s_lshl_b32 s52, s52, 10
    s_add_u32 s52, s52, 10485760
    s_lshl_b32 s50, s60, 7
    s_add_u32 s50, s50, s53
    s_add_u32 s50, s50, s55
    s_lshl_b32 s50, s50, 7
    s_add_u32 s50, s50, 1310720
    s_waitcnt lgkmcnt(0)
    ds_read_b64_tr_b16 v[64:65], v15 offset:0
    ds_read_b64_tr_b16 v[66:67], v15 offset:256
    ds_read_b64_tr_b16 v[68:69], v15 offset:1024
    ds_read_b64_tr_b16 v[70:71], v15 offset:1280
    s_waitcnt lgkmcnt(2)
    buffer_store_dwordx4 v[64:67], v2, s[32:35], s52 offen offset:0 sc1
    s_waitcnt lgkmcnt(0)
    buffer_store_dwordx4 v[68:71], v2, s[32:35], s52 offen offset:1024 sc1
    s_lshl_b32 s51, s22, 18
    s_lshl_b32 s52, s3, 15
    s_add_u32 s51, s51, s52
    s_add_u32 s51, s51, 10485760
    s_lshl_b32 s66, s22, 14
    s_lshl_b32 s52, s3, 12
    s_add_u32 s66, s66, s52
    s_add_u32 s66, s66, 1310720
    s_mov_b32 s57, s50
    s_add_u32 s40, s24, s51
    s_addc_u32 s41, s25, 0
    s_mov_b32 s42, 262144
    s_mov_b32 s43, 0x20000
    s_lshr_b32 s56, s3, 1
    s_mul_i32 s50, s56, 131072
    s_xor_b32 s51, s56, 1
    s_mul_i32 s51, s51, 131072
    v_add_u32 v242, s50, v2
    v_add_u32 v243, s51, v2
    v_and_b32 v6, 31, v1
    v_lshlrev_b32 v6, 7, v6
    s_waitcnt vmcnt(0)
    v_mov_b32 v3, s26
    v_mov_b32 v4, 0
    s_mov_b64 exec, 1
    buffer_store_dword v3, v4, s[32:35], s57 offen sc1
    s_mov_b64 exec, -1
    s_add_u32 m0, s96, 0
    s_mov_b32 s48, 1490944
    buffer_load_dwordx4 v244, s[44:47], s48 offen lds
    buffer_load_dwordx4 v245, s[44:47], s48 offen offset:1024 lds
    s_add_u32 m0, s96, 2048
    s_mov_b32 s48, 1548288
    buffer_load_dwordx4 v244, s[44:47], s48 offen lds
    buffer_load_dwordx4 v245, s[44:47], s48 offen offset:1024 lds
    s_add_u32 m0, s96, 4096
    s_mov_b32 s48, 1605632
    buffer_load_dwordx4 v244, s[44:47], s48 offen lds
    buffer_load_dwordx4 v245, s[44:47], s48 offen offset:1024 lds
    s_add_u32 m0, s96, 6144
    s_mov_b32 s48, 1662976
    buffer_load_dwordx4 v244, s[44:47], s48 offen lds
    buffer_load_dwordx4 v245, s[44:47], s48 offen offset:1024 lds
    s_add_u32 m0, s96, 8192
    s_mov_b32 s48, 1720320
    buffer_load_dwordx4 v244, s[44:47], s48 offen lds
    buffer_load_dwordx4 v245, s[44:47], s48 offen offset:1024 lds
    s_add_u32 m0, s96, 10240
    s_mov_b32 s48, 1777664
    buffer_load_dwordx4 v244, s[44:47], s48 offen lds
    buffer_load_dwordx4 v245, s[44:47], s48 offen offset:1024 lds
    s_waitcnt vmcnt(10)
    ds_read_b64_tr_b16 a[208:209], v240 offset:0
    ds_read_b64_tr_b16 a[210:211], v240 offset:512
    ds_read_b64_tr_b16 a[212:213], v241 offset:0
    ds_read_b64_tr_b16 a[214:215], v241 offset:512
    s_waitcnt vmcnt(8)
    ds_read_b64_tr_b16 a[216:217], v240 offset:2048
    ds_read_b64_tr_b16 a[218:219], v240 offset:2560
    ds_read_b64_tr_b16 a[220:221], v241 offset:2048
    ds_read_b64_tr_b16 a[222:223], v241 offset:2560
    s_waitcnt vmcnt(6)
    ds_read_b64_tr_b16 a[224:225], v240 offset:4096
    ds_read_b64_tr_b16 a[226:227], v240 offset:4608
    ds_read_b64_tr_b16 a[228:229], v241 offset:4096
    ds_read_b64_tr_b16 a[230:231], v241 offset:4608
    s_waitcnt vmcnt(4)
    ds_read_b64_tr_b16 a[232:233], v240 offset:6144
    ds_read_b64_tr_b16 a[234:235], v240 offset:6656
    ds_read_b64_tr_b16 a[236:237], v241 offset:6144
    ds_read_b64_tr_b16 a[238:239], v241 offset:6656
    s_waitcnt vmcnt(2)
    ds_read_b64_tr_b16 a[240:241], v240 offset:8192
    ds_read_b64_tr_b16 a[242:243], v240 offset:8704
    ds_read_b64_tr_b16 a[244:245], v241 offset:8192
    ds_read_b64_tr_b16 a[246:247], v241 offset:8704
    s_waitcnt vmcnt(0)
    ds_read_b64_tr_b16 a[248:249], v240 offset:10240
    ds_read_b64_tr_b16 a[250:251], v240 offset:10752
    ds_read_b64_tr_b16 a[252:253], v241 offset:10240
    ds_read_b64_tr_b16 a[254:255], v241 offset:10752
    s_mul_i32 s96, s3, 28672
    s_lshl_b32 s67, s23, 3
    s_add_u32 s67, s67, s10
    s_mul_i32 s50, s3, 1835008
    s_lshl_b32 s51, s67, 7
    s_add_u32 s50, s50, s51
    s_sub_u32 s51, 7340032, s50
    s_add_u32 s44, s16, s50
    s_addc_u32 s45, s17, 0
    s_mov_b32 s46, s51
    s_mov_b32 s47, 0x20000
    v_lshrrev_b32 v3, 3, v1
    v_mul_u32_u24 v3, 4096, v3
    v_and_b32 v4, 7, v1
    v_bfe_u32 v5, v1, 4, 1
    v_lshlrev_b32 v5, 2, v5
    v_xor_b32 v4, v4, v5
    v_lshl_add_u32 v244, v4, 4, v3
    v_add_u32 v245, 31744, v244
    v_lshrrev_b32 v3, 5, v1
    v_bfe_u32 v4, v1, 2, 2
    v_lshl_add_u32 v4, v3, 2, v4
    v_lshlrev_b32 v4, 7, v4
    v_bfe_u32 v5, v1, 4, 1
    v_lshl_add_u32 v4, v5, 5, v4
    v_and_b32 v5, 3, v1
    v_lshl_add_u32 v4, v5, 3, v4
    v_add_u32 v4, s96, v4
    v_bfe_u32 v5, v1, 3, 1
    v_xor_b32 v5, s55, v5
    v_lshl_add_u32 v240, v5, 6, v4
    v_xor_b32 v5, 1, v5
    v_lshl_add_u32 v241, v5, 6, v4
    s_waitcnt lgkmcnt(0)
    s_barrier
    s_cmp_ge_u32 s10, 7
    s_cbranch_scc1 sequential_preLN__sliding_block__mixer_token_mlp__prompt_kernel_nonD2
    s_mov_b32 s98, 0
    s_mov_b32 s58, 0xffffffff
    s_mov_b32 s59, 0
sequential_preLN__sliding_block__mixer_token_mlp__prompt_kernel_poll40:
    s_mov_b64 exec, s[58:59]
    buffer_load_dword v3, v6, s[32:35], s66 offen sc1
    s_waitcnt vmcnt(0)
    v_cmp_ne_u32 s[58:59], s26, v3
    s_ff1_i32_b32 s99, s58
    s_cmp_lt_i32 s99, 0
    s_cbranch_scc1 sequential_preLN__sliding_block__mixer_token_mlp__prompt_kernel_got42
    s_lshl_b64 exec, 1, s99
    s_andn2_b64 s[58:59], s[58:59], exec
sequential_preLN__sliding_block__mixer_token_mlp__prompt_kernel_one41:
    buffer_load_dword v3, v6, s[32:35], s66 offen sc1
    s_add_u32 s98, s98, 1
    s_waitcnt vmcnt(0)
    v_cmp_ne_u32 vcc, s26, v3
    s_cmp_gt_u32 s98, 30000
    s_cbranch_scc1 sequential_preLN__sliding_block__mixer_token_mlp__prompt_kernel_got42
    s_cbranch_vccnz sequential_preLN__sliding_block__mixer_token_mlp__prompt_kernel_one41
    s_cmp_lg_u32 s58, 0
    s_cbranch_scc1 sequential_preLN__sliding_block__mixer_token_mlp__prompt_kernel_poll40
sequential_preLN__sliding_block__mixer_token_mlp__prompt_kernel_got42:
    s_mov_b64 exec, -1
    s_movk_i32 s49, 0
    buffer_load_dwordx4 v[80:83], v242, s[40:43], s49 offen offset:0 sc1
    buffer_load_dwordx4 v[84:87], v243, s[40:43], s49 offen offset:0 sc1
    buffer_load_dwordx4 v[88:91], v242, s[40:43], s49 offen offset:1024 sc1
    buffer_load_dwordx4 v[92:95], v243, s[40:43], s49 offen offset:1024 sc1
    buffer_load_dwordx4 v[96:99], v242, s[40:43], s49 offen offset:2048 sc1
    buffer_load_dwordx4 v[100:103], v243, s[40:43], s49 offen offset:2048 sc1
    buffer_load_dwordx4 v[104:107], v242, s[40:43], s49 offen offset:3072 sc1
    buffer_load_dwordx4 v[108:111], v243, s[40:43], s49 offen offset:3072 sc1
    s_movk_i32 s49, 4096
    buffer_load_dwordx4 v[112:115], v242, s[40:43], s49 offen offset:0 sc1
    buffer_load_dwordx4 v[116:119], v243, s[40:43], s49 offen offset:0 sc1
    buffer_load_dwordx4 v[120:123], v242, s[40:43], s49 offen offset:1024 sc1
    buffer_load_dwordx4 v[124:127], v243, s[40:43], s49 offen offset:1024 sc1
    s_waitcnt vmcnt(10)
    v_mfma_f32_32x32x16_bf16 v[16:31], a[0:3], v[80:83], 0
    v_mfma_f32_32x32x16_bf16 v[32:47], a[4:7], v[80:83], 0
    v_mfma_f32_32x32x16_bf16 v[48:63], a[0:3], v[84:87], 0
    v_mfma_f32_32x32x16_bf16 v[64:79], a[4:7], v[84:87], 0
    buffer_load_dwordx4 v[80:83], v242, s[40:43], s49 offen offset:2048 sc1
    buffer_load_dwordx4 v[84:87], v243, s[40:43], s49 offen offset:2048 sc1
    s_waitcnt vmcnt(10)
    v_mfma_f32_32x32x16_bf16 v[16:31], a[8:11], v[88:91], v[16:31]
    v_mfma_f32_32x32x16_bf16 v[32:47], a[12:15], v[88:91], v[32:47]
    v_mfma_f32_32x32x16_bf16 v[48:63], a[8:11], v[92:95], v[48:63]
    v_mfma_f32_32x32x16_bf16 v[64:79], a[12:15], v[92:95], v[64:79]
    buffer_load_dwordx4 v[88:91], v242, s[40:43], s49 offen offset:3072 sc1
    buffer_load_dwordx4 v[92:95], v243, s[40:43], s49 offen offset:3072 sc1
    s_waitcnt vmcnt(10)
    v_mfma_f32_32x32x16_bf16 v[16:31], a[16:19], v[96:99], v[16:31]
    v_mfma_f32_32x32x16_bf16 v[32:47], a[20:23], v[96:99], v[32:47]
    v_mfma_f32_32x32x16_bf16 v[48:63], a[16:19], v[100:103], v[48:63]
    v_mfma_f32_32x32x16_bf16 v[64:79], a[20:23], v[100:103], v[64:79]
    s_movk_i32 s49, 8192
    buffer_load_dwordx4 v[96:99], v242, s[40:43], s49 offen offset:0 sc1
    buffer_load_dwordx4 v[100:103], v243, s[40:43], s49 offen offset:0 sc1
    s_waitcnt vmcnt(10)
    v_mfma_f32_32x32x16_bf16 v[16:31], a[24:27], v[104:107], v[16:31]
    v_mfma_f32_32x32x16_bf16 v[32:47], a[28:31], v[104:107], v[32:47]
    v_mfma_f32_32x32x16_bf16 v[48:63], a[24:27], v[108:111], v[48:63]
    v_mfma_f32_32x32x16_bf16 v[64:79], a[28:31], v[108:111], v[64:79]
    buffer_load_dwordx4 v[104:107], v242, s[40:43], s49 offen offset:1024 sc1
    buffer_load_dwordx4 v[108:111], v243, s[40:43], s49 offen offset:1024 sc1
    s_waitcnt vmcnt(10)
    v_mfma_f32_32x32x16_bf16 v[16:31], a[32:35], v[112:115], v[16:31]
    v_mfma_f32_32x32x16_bf16 v[32:47], a[36:39], v[112:115], v[32:47]
    v_mfma_f32_32x32x16_bf16 v[48:63], a[32:35], v[116:119], v[48:63]
    v_mfma_f32_32x32x16_bf16 v[64:79], a[36:39], v[116:119], v[64:79]
    buffer_load_dwordx4 v[112:115], v242, s[40:43], s49 offen offset:2048 sc1
    buffer_load_dwordx4 v[116:119], v243, s[40:43], s49 offen offset:2048 sc1
    s_waitcnt vmcnt(10)
    v_mfma_f32_32x32x16_bf16 v[16:31], a[40:43], v[120:123], v[16:31]
    v_mfma_f32_32x32x16_bf16 v[32:47], a[44:47], v[120:123], v[32:47]
    v_mfma_f32_32x32x16_bf16 v[48:63], a[40:43], v[124:127], v[48:63]
    v_mfma_f32_32x32x16_bf16 v[64:79], a[44:47], v[124:127], v[64:79]
    buffer_load_dwordx4 v[120:123], v242, s[40:43], s49 offen offset:3072 sc1
    buffer_load_dwordx4 v[124:127], v243, s[40:43], s49 offen offset:3072 sc1
    s_waitcnt vmcnt(10)
    v_mfma_f32_32x32x16_bf16 v[16:31], a[48:51], v[80:83], v[16:31]
    v_mfma_f32_32x32x16_bf16 v[32:47], a[52:55], v[80:83], v[32:47]
    v_mfma_f32_32x32x16_bf16 v[48:63], a[48:51], v[84:87], v[48:63]
    v_mfma_f32_32x32x16_bf16 v[64:79], a[52:55], v[84:87], v[64:79]
    s_movk_i32 s49, 12288
    buffer_load_dwordx4 v[80:83], v242, s[40:43], s49 offen offset:0 sc1
    buffer_load_dwordx4 v[84:87], v243, s[40:43], s49 offen offset:0 sc1
    s_waitcnt vmcnt(10)
    v_mfma_f32_32x32x16_bf16 v[16:31], a[56:59], v[88:91], v[16:31]
    v_mfma_f32_32x32x16_bf16 v[32:47], a[60:63], v[88:91], v[32:47]
    v_mfma_f32_32x32x16_bf16 v[48:63], a[56:59], v[92:95], v[48:63]
    v_mfma_f32_32x32x16_bf16 v[64:79], a[60:63], v[92:95], v[64:79]
    buffer_load_dwordx4 v[88:91], v242, s[40:43], s49 offen offset:1024 sc1
    buffer_load_dwordx4 v[92:95], v243, s[40:43], s49 offen offset:1024 sc1
    s_waitcnt vmcnt(10)
    v_mfma_f32_32x32x16_bf16 v[16:31], a[64:67], v[96:99], v[16:31]
    v_mfma_f32_32x32x16_bf16 v[32:47], a[68:71], v[96:99], v[32:47]
    v_mfma_f32_32x32x16_bf16 v[48:63], a[64:67], v[100:103], v[48:63]
    v_mfma_f32_32x32x16_bf16 v[64:79], a[68:71], v[100:103], v[64:79]
    buffer_load_dwordx4 v[96:99], v242, s[40:43], s49 offen offset:2048 sc1
    buffer_load_dwordx4 v[100:103], v243, s[40:43], s49 offen offset:2048 sc1
    s_waitcnt vmcnt(10)
    v_mfma_f32_32x32x16_bf16 v[16:31], a[72:75], v[104:107], v[16:31]
    v_mfma_f32_32x32x16_bf16 v[32:47], a[76:79], v[104:107], v[32:47]
    v_mfma_f32_32x32x16_bf16 v[48:63], a[72:75], v[108:111], v[48:63]
    v_mfma_f32_32x32x16_bf16 v[64:79], a[76:79], v[108:111], v[64:79]
    buffer_load_dwordx4 v[104:107], v242, s[40:43], s49 offen offset:3072 sc1
    buffer_load_dwordx4 v[108:111], v243, s[40:43], s49 offen offset:3072 sc1
    s_waitcnt vmcnt(10)
    v_mfma_f32_32x32x16_bf16 v[16:31], a[80:83], v[112:115], v[16:31]
    v_mfma_f32_32x32x16_bf16 v[32:47], a[84:87], v[112:115], v[32:47]
    v_mfma_f32_32x32x16_bf16 v[48:63], a[80:83], v[116:119], v[48:63]
    v_mfma_f32_32x32x16_bf16 v[64:79], a[84:87], v[116:119], v[64:79]
    s_movk_i32 s49, 16384
    buffer_load_dwordx4 v[112:115], v242, s[40:43], s49 offen offset:0 sc1
    buffer_load_dwordx4 v[116:119], v243, s[40:43], s49 offen offset:0 sc1
    s_waitcnt vmcnt(10)
    v_mfma_f32_32x32x16_bf16 v[16:31], a[88:91], v[120:123], v[16:31]
    v_mfma_f32_32x32x16_bf16 v[32:47], a[92:95], v[120:123], v[32:47]
    v_mfma_f32_32x32x16_bf16 v[48:63], a[88:91], v[124:127], v[48:63]
    v_mfma_f32_32x32x16_bf16 v[64:79], a[92:95], v[124:127], v[64:79]
    buffer_load_dwordx4 v[120:123], v242, s[40:43], s49 offen offset:1024 sc1
    buffer_load_dwordx4 v[124:127], v243, s[40:43], s49 offen offset:1024 sc1
    s_waitcnt vmcnt(10)
    v_mfma_f32_32x32x16_bf16 v[16:31], a[96:99], v[80:83], v[16:31]
    v_mfma_f32_32x32x16_bf16 v[32:47], a[100:103], v[80:83], v[32:47]
    v_mfma_f32_32x32x16_bf16 v[48:63], a[96:99], v[84:87], v[48:63]
    v_mfma_f32_32x32x16_bf16 v[64:79], a[100:103], v[84:87], v[64:79]
    buffer_load_dwordx4 v[80:83], v242, s[40:43], s49 offen offset:2048 sc1
    buffer_load_dwordx4 v[84:87], v243, s[40:43], s49 offen offset:2048 sc1
    s_waitcnt vmcnt(10)
    v_mfma_f32_32x32x16_bf16 v[16:31], a[104:107], v[88:91], v[16:31]
    v_mfma_f32_32x32x16_bf16 v[32:47], a[108:111], v[88:91], v[32:47]
    v_mfma_f32_32x32x16_bf16 v[48:63], a[104:107], v[92:95], v[48:63]
    v_mfma_f32_32x32x16_bf16 v[64:79], a[108:111], v[92:95], v[64:79]
    buffer_load_dwordx4 v[88:91], v242, s[40:43], s49 offen offset:3072 sc1
    buffer_load_dwordx4 v[92:95], v243, s[40:43], s49 offen offset:3072 sc1
    s_waitcnt vmcnt(10)
    v_mfma_f32_32x32x16_bf16 v[16:31], a[112:115], v[96:99], v[16:31]
    v_mfma_f32_32x32x16_bf16 v[32:47], a[116:119], v[96:99], v[32:47]
    v_mfma_f32_32x32x16_bf16 v[48:63], a[112:115], v[100:103], v[48:63]
    v_mfma_f32_32x32x16_bf16 v[64:79], a[116:119], v[100:103], v[64:79]
    s_movk_i32 s49, 20480
    buffer_load_dwordx4 v[96:99], v242, s[40:43], s49 offen offset:0 sc1
    buffer_load_dwordx4 v[100:103], v243, s[40:43], s49 offen offset:0 sc1
    s_waitcnt vmcnt(10)
    v_mfma_f32_32x32x16_bf16 v[16:31], a[120:123], v[104:107], v[16:31]
    v_mfma_f32_32x32x16_bf16 v[32:47], a[124:127], v[104:107], v[32:47]
    v_mfma_f32_32x32x16_bf16 v[48:63], a[120:123], v[108:111], v[48:63]
    v_mfma_f32_32x32x16_bf16 v[64:79], a[124:127], v[108:111], v[64:79]
    buffer_load_dwordx4 v[104:107], v242, s[40:43], s49 offen offset:1024 sc1
    buffer_load_dwordx4 v[108:111], v243, s[40:43], s49 offen offset:1024 sc1
    s_waitcnt vmcnt(10)
    v_mfma_f32_32x32x16_bf16 v[16:31], a[128:131], v[112:115], v[16:31]
    v_mfma_f32_32x32x16_bf16 v[32:47], a[132:135], v[112:115], v[32:47]
    v_mfma_f32_32x32x16_bf16 v[48:63], a[128:131], v[116:119], v[48:63]
    v_mfma_f32_32x32x16_bf16 v[64:79], a[132:135], v[116:119], v[64:79]
    buffer_load_dwordx4 v[112:115], v242, s[40:43], s49 offen offset:2048 sc1
    buffer_load_dwordx4 v[116:119], v243, s[40:43], s49 offen offset:2048 sc1
    s_waitcnt vmcnt(10)
    v_mfma_f32_32x32x16_bf16 v[16:31], a[136:139], v[120:123], v[16:31]
    v_mfma_f32_32x32x16_bf16 v[32:47], a[140:143], v[120:123], v[32:47]
    v_mfma_f32_32x32x16_bf16 v[48:63], a[136:139], v[124:127], v[48:63]
    v_mfma_f32_32x32x16_bf16 v[64:79], a[140:143], v[124:127], v[64:79]
    buffer_load_dwordx4 v[120:123], v242, s[40:43], s49 offen offset:3072 sc1
    buffer_load_dwordx4 v[124:127], v243, s[40:43], s49 offen offset:3072 sc1
    s_waitcnt vmcnt(10)
    v_mfma_f32_32x32x16_bf16 v[16:31], a[144:147], v[80:83], v[16:31]
    v_mfma_f32_32x32x16_bf16 v[32:47], a[148:151], v[80:83], v[32:47]
    v_mfma_f32_32x32x16_bf16 v[48:63], a[144:147], v[84:87], v[48:63]
    v_mfma_f32_32x32x16_bf16 v[64:79], a[148:151], v[84:87], v[64:79]
    s_movk_i32 s49, 24576
    buffer_load_dwordx4 v[80:83], v242, s[40:43], s49 offen offset:0 sc1
    buffer_load_dwordx4 v[84:87], v243, s[40:43], s49 offen offset:0 sc1
    s_waitcnt vmcnt(10)
    v_mfma_f32_32x32x16_bf16 v[16:31], a[152:155], v[88:91], v[16:31]
    v_mfma_f32_32x32x16_bf16 v[32:47], a[156:159], v[88:91], v[32:47]
    v_mfma_f32_32x32x16_bf16 v[48:63], a[152:155], v[92:95], v[48:63]
    v_mfma_f32_32x32x16_bf16 v[64:79], a[156:159], v[92:95], v[64:79]
    buffer_load_dwordx4 v[88:91], v242, s[40:43], s49 offen offset:1024 sc1
    buffer_load_dwordx4 v[92:95], v243, s[40:43], s49 offen offset:1024 sc1
    s_waitcnt vmcnt(10)
    v_mfma_f32_32x32x16_bf16 v[16:31], a[160:163], v[96:99], v[16:31]
    v_mfma_f32_32x32x16_bf16 v[32:47], a[164:167], v[96:99], v[32:47]
    v_mfma_f32_32x32x16_bf16 v[48:63], a[160:163], v[100:103], v[48:63]
    v_mfma_f32_32x32x16_bf16 v[64:79], a[164:167], v[100:103], v[64:79]
    buffer_load_dwordx4 v[96:99], v242, s[40:43], s49 offen offset:2048 sc1
    buffer_load_dwordx4 v[100:103], v243, s[40:43], s49 offen offset:2048 sc1
    s_waitcnt vmcnt(10)
    v_mfma_f32_32x32x16_bf16 v[16:31], a[168:171], v[104:107], v[16:31]
    v_mfma_f32_32x32x16_bf16 v[32:47], a[172:175], v[104:107], v[32:47]
    v_mfma_f32_32x32x16_bf16 v[48:63], a[168:171], v[108:111], v[48:63]
    v_mfma_f32_32x32x16_bf16 v[64:79], a[172:175], v[108:111], v[64:79]
    buffer_load_dwordx4 v[104:107], v242, s[40:43], s49 offen offset:3072 sc1
    buffer_load_dwordx4 v[108:111], v243, s[40:43], s49 offen offset:3072 sc1
    s_waitcnt vmcnt(10)
    v_mfma_f32_32x32x16_bf16 v[16:31], a[176:179], v[112:115], v[16:31]
    v_mfma_f32_32x32x16_bf16 v[32:47], a[180:183], v[112:115], v[32:47]
    v_mfma_f32_32x32x16_bf16 v[48:63], a[176:179], v[116:119], v[48:63]
    v_mfma_f32_32x32x16_bf16 v[64:79], a[180:183], v[116:119], v[64:79]
    s_movk_i32 s49, 28672
    buffer_load_dwordx4 v[112:115], v242, s[40:43], s49 offen offset:0 sc1
    buffer_load_dwordx4 v[116:119], v243, s[40:43], s49 offen offset:0 sc1
    s_waitcnt vmcnt(10)
    v_mfma_f32_32x32x16_bf16 v[16:31], a[184:187], v[120:123], v[16:31]
    v_mfma_f32_32x32x16_bf16 v[32:47], a[188:191], v[120:123], v[32:47]
    v_mfma_f32_32x32x16_bf16 v[48:63], a[184:187], v[124:127], v[48:63]
    v_mfma_f32_32x32x16_bf16 v[64:79], a[188:191], v[124:127], v[64:79]
    buffer_load_dwordx4 v[120:123], v242, s[40:43], s49 offen offset:1024 sc1
    buffer_load_dwordx4 v[124:127], v243, s[40:43], s49 offen offset:1024 sc1
    s_waitcnt vmcnt(10)
    v_mfma_f32_32x32x16_bf16 v[16:31], a[192:195], v[80:83], v[16:31]
    v_mfma_f32_32x32x16_bf16 v[32:47], a[196:199], v[80:83], v[32:47]
    v_mfma_f32_32x32x16_bf16 v[48:63], a[192:195], v[84:87], v[48:63]
    v_mfma_f32_32x32x16_bf16 v[64:79], a[196:199], v[84:87], v[64:79]
    buffer_load_dwordx4 v[80:83], v242, s[40:43], s49 offen offset:2048 sc1
    buffer_load_dwordx4 v[84:87], v243, s[40:43], s49 offen offset:2048 sc1
    s_waitcnt vmcnt(10)
    v_mfma_f32_32x32x16_bf16 v[16:31], a[200:203], v[88:91], v[16:31]
    v_mfma_f32_32x32x16_bf16 v[32:47], a[204:207], v[88:91], v[32:47]
    v_mfma_f32_32x32x16_bf16 v[48:63], a[200:203], v[92:95], v[48:63]
    v_mfma_f32_32x32x16_bf16 v[64:79], a[204:207], v[92:95], v[64:79]
    buffer_load_dwordx4 v[88:91], v242, s[40:43], s49 offen offset:3072 sc1
    buffer_load_dwordx4 v[92:95], v243, s[40:43], s49 offen offset:3072 sc1
    s_waitcnt vmcnt(10)
    v_mfma_f32_32x32x16_bf16 v[16:31], a[208:211], v[96:99], v[16:31]
    v_mfma_f32_32x32x16_bf16 v[32:47], a[212:215], v[96:99], v[32:47]
    v_mfma_f32_32x32x16_bf16 v[48:63], a[208:211], v[100:103], v[48:63]
    v_mfma_f32_32x32x16_bf16 v[64:79], a[212:215], v[100:103], v[64:79]
    s_add_u32 m0, s96, 0
    s_mov_b32 s48, 0
    buffer_load_dwordx4 v244, s[44:47], s48 offen lds
    buffer_load_dwordx4 v245, s[44:47], s48 offen offset:1024 lds
    s_waitcnt vmcnt(10)
    v_mfma_f32_32x32x16_bf16 v[16:31], a[216:219], v[104:107], v[16:31]
    v_mfma_f32_32x32x16_bf16 v[32:47], a[220:223], v[104:107], v[32:47]
    v_mfma_f32_32x32x16_bf16 v[48:63], a[216:219], v[108:111], v[48:63]
    v_mfma_f32_32x32x16_bf16 v[64:79], a[220:223], v[108:111], v[64:79]
    s_add_u32 m0, s96, 2048
    s_mov_b32 s48, 65536
    buffer_load_dwordx4 v244, s[44:47], s48 offen lds
    buffer_load_dwordx4 v245, s[44:47], s48 offen offset:1024 lds
    s_waitcnt vmcnt(10)
    v_mfma_f32_32x32x16_bf16 v[16:31], a[224:227], v[112:115], v[16:31]
    v_mfma_f32_32x32x16_bf16 v[32:47], a[228:231], v[112:115], v[32:47]
    v_mfma_f32_32x32x16_bf16 v[48:63], a[224:227], v[116:119], v[48:63]
    v_mfma_f32_32x32x16_bf16 v[64:79], a[228:231], v[116:119], v[64:79]
    s_add_u32 m0, s96, 4096
    s_mov_b32 s48, 131072
    buffer_load_dwordx4 v244, s[44:47], s48 offen lds
    buffer_load_dwordx4 v245, s[44:47], s48 offen offset:1024 lds
    s_waitcnt vmcnt(10)
    v_mfma_f32_32x32x16_bf16 v[16:31], a[232:235], v[120:123], v[16:31]
    v_mfma_f32_32x32x16_bf16 v[32:47], a[236:239], v[120:123], v[32:47]
    v_mfma_f32_32x32x16_bf16 v[48:63], a[232:235], v[124:127], v[48:63]
    v_mfma_f32_32x32x16_bf16 v[64:79], a[236:239], v[124:127], v[64:79]
    s_add_u32 m0, s96, 6144
    s_mov_b32 s48, 196608
    buffer_load_dwordx4 v244, s[44:47], s48 offen lds
    buffer_load_dwordx4 v245, s[44:47], s48 offen offset:1024 lds
    s_waitcnt vmcnt(10)
    v_mfma_f32_32x32x16_bf16 v[16:31], a[240:243], v[80:83], v[16:31]
    v_mfma_f32_32x32x16_bf16 v[32:47], a[244:247], v[80:83], v[32:47]
    v_mfma_f32_32x32x16_bf16 v[48:63], a[240:243], v[84:87], v[48:63]
    v_mfma_f32_32x32x16_bf16 v[64:79], a[244:247], v[84:87], v[64:79]
    s_add_u32 m0, s96, 8192
    s_mov_b32 s48, 262144
    buffer_load_dwordx4 v244, s[44:47], s48 offen lds
    buffer_load_dwordx4 v245, s[44:47], s48 offen offset:1024 lds
    s_waitcnt vmcnt(10)
    v_mfma_f32_32x32x16_bf16 v[16:31], a[248:251], v[88:91], v[16:31]
    v_mfma_f32_32x32x16_bf16 v[32:47], a[252:255], v[88:91], v[32:47]
    v_mfma_f32_32x32x16_bf16 v[48:63], a[248:251], v[92:95], v[48:63]
    v_mfma_f32_32x32x16_bf16 v[64:79], a[252:255], v[92:95], v[64:79]
    s_add_u32 m0, s96, 10240
    s_mov_b32 s48, 327680
    buffer_load_dwordx4 v244, s[44:47], s48 offen lds
    buffer_load_dwordx4 v245, s[44:47], s48 offen offset:1024 lds
    s_xor_b32 s50, s3, 1
    s_mul_i32 s50, s50, 12288
    s_add_u32 s50, s50, 114688
    v_add_u32 v4, s50, v2
    s_xor_b32 s50, s3, 2
    s_mul_i32 s50, s50, 12288
    s_add_u32 s50, s50, 118784
    v_add_u32 v5, s50, v2
    s_xor_b32 s50, s3, 3
    s_mul_i32 s50, s50, 12288
    s_add_u32 s50, s50, 122880
    v_add_u32 v6, s50, v2
    s_mul_i32 s50, s3, 12288
    s_add_u32 s50, s50, 114688
    v_add_u32 v7, s50, v2
    ds_write_b128 v4, v[32:35] offset:0
    ds_write_b128 v4, v[36:39] offset:1024
    ds_write_b128 v4, v[40:43] offset:2048
    ds_write_b128 v4, v[44:47] offset:3072
    ds_write_b128 v5, v[48:51] offset:0
    ds_write_b128 v5, v[52:55] offset:1024
    ds_write_b128 v5, v[56:59] offset:2048
    ds_write_b128 v5, v[60:63] offset:3072
    ds_write_b128 v6, v[64:67] offset:0
    ds_write_b128 v6, v[68:71] offset:1024
    ds_write_b128 v6, v[72:75] offset:2048
    ds_write_b128 v6, v[76:79] offset:3072
    s_add_u32 m0, s96, 12288
    s_mov_b32 s48, 393216
    buffer_load_dwordx4 v244, s[44:47], s48 offen lds
    buffer_load_dwordx4 v245, s[44:47], s48 offen offset:1024 lds
    s_add_u32 m0, s96, 14336
    s_mov_b32 s48, 458752
    buffer_load_dwordx4 v244, s[44:47], s48 offen lds
    buffer_load_dwordx4 v245, s[44:47], s48 offen offset:1024 lds
    s_add_u32 m0, s96, 16384
    s_mov_b32 s48, 524288
    buffer_load_dwordx4 v244, s[44:47], s48 offen lds
    buffer_load_dwordx4 v245, s[44:47], s48 offen offset:1024 lds
    s_add_u32 m0, s96, 18432
    s_mov_b32 s48, 589824
    buffer_load_dwordx4 v244, s[44:47], s48 offen lds
    buffer_load_dwordx4 v245, s[44:47], s48 offen offset:1024 lds
    s_add_u32 m0, s96, 20480
    s_mov_b32 s48, 655360
    buffer_load_dwordx4 v244, s[44:47], s48 offen lds
    buffer_load_dwordx4 v245, s[44:47], s48 offen offset:1024 lds
    s_add_u32 m0, s96, 22528
    s_mov_b32 s48, 720896
    buffer_load_dwordx4 v244, s[44:47], s48 offen lds
    buffer_load_dwordx4 v245, s[44:47], s48 offen offset:1024 lds
    s_add_u32 m0, s96, 24576
    s_mov_b32 s48, 786432
    buffer_load_dwordx4 v244, s[44:47], s48 offen lds
    buffer_load_dwordx4 v245, s[44:47], s48 offen offset:1024 lds
    s_add_u32 m0, s96, 26624
    s_mov_b32 s48, 851968
    buffer_load_dwordx4 v244, s[44:47], s48 offen lds
    buffer_load_dwordx4 v245, s[44:47], s48 offen offset:1024 lds
    v_mov_b32 v8, 0xbdd2d3e8
    s_mul_i32 s50, s23, 7
    s_add_u32 s50, s50, s10
    s_lshl_b32 s50, s50, 1
    s_add_u32 s50, s50, s55
    s_lshl_b32 s51, s22, 1
    s_add_u32 s51, s51, s56
    s_mul_i32 s52, s51, 56
    s_add_u32 s52, s52, s50
    s_lshl_b32 s52, s52, 11
    s_add_u32 s52, s52, 12582912
    s_mul_i32 s57, s22, 112
    s_lshl_b32 s50, s50, 1
    s_add_u32 s57, s57, s50
    s_add_u32 s57, s57, s56
    s_lshl_b32 s57, s57, 7
    s_add_u32 s57, s57, 1441792
    v_lshlrev_b32 v10, 16, v246
    v_and_b32 v11, 0xffff0000, v246
    v_pk_add_f32 v[16:17], v[16:17], v[10:11]
    v_lshlrev_b32 v10, 16, v247
    v_and_b32 v11, 0xffff0000, v247
    v_pk_add_f32 v[18:19], v[18:19], v[10:11]
    v_lshlrev_b32 v10, 16, v248
    v_and_b32 v11, 0xffff0000, v248
    v_pk_add_f32 v[20:21], v[20:21], v[10:11]
    v_lshlrev_b32 v10, 16, v249
    v_and_b32 v11, 0xffff0000, v249
    v_pk_add_f32 v[22:23], v[22:23], v[10:11]
    v_lshlrev_b32 v10, 16, v250
    v_and_b32 v11, 0xffff0000, v250
    v_pk_add_f32 v[24:25], v[24:25], v[10:11]
    v_lshlrev_b32 v10, 16, v251
    v_and_b32 v11, 0xffff0000, v251
    v_pk_add_f32 v[26:27], v[26:27], v[10:11]
    v_lshlrev_b32 v10, 16, v252
    v_and_b32 v11, 0xffff0000, v252
    v_pk_add_f32 v[28:29], v[28:29], v[10:11]
    v_lshlrev_b32 v10, 16, v253
    v_and_b32 v11, 0xffff0000, v253
    v_pk_add_f32 v[30:31], v[30:31], v[10:11]
    s_waitcnt lgkmcnt(0)
    s_barrier
    ds_read_b128 v[32:35], v7 offset:0
    ds_read_b128 v[48:51], v7 offset:4096
    ds_read_b128 v[64:67], v7 offset:8192
    ds_read_b128 v[36:39], v7 offset:1024
    ds_read_b128 v[52:55], v7 offset:5120
    ds_read_b128 v[68:71], v7 offset:9216
    ds_read_b128 v[40:43], v7 offset:2048
    ds_read_b128 v[56:59], v7 offset:6144
    ds_read_b128 v[72:75], v7 offset:10240
    ds_read_b128 v[44:47], v7 offset:3072
    ds_read_b128 v[60:63], v7 offset:7168
    ds_read_b128 v[76:79], v7 offset:11264
    s_waitcnt lgkmcnt(11)
    v_pk_add_f32 v[16:17], v[16:17], v[32:33]
    v_pk_add_f32 v[18:19], v[18:19], v[34:35]
    s_waitcnt lgkmcnt(10)
    v_pk_add_f32 v[16:17], v[16:17], v[48:49]
    v_pk_add_f32 v[18:19], v[18:19], v[50:51]
    s_waitcnt lgkmcnt(9)
    v_pk_add_f32 v[16:17], v[16:17], v[64:65]
    v_pk_add_f32 v[18:19], v[18:19], v[66:67]
    v_mul_f32 v160, v16, v16
    v_mul_f32 v161, v17, v17
    v_mul_f32 v162, v18, v18
    v_mul_f32 v163, v19, v19
    v_fmaak_f32 v160, v160, v8, 0xc0135761
    v_fmaak_f32 v161, v161, v8, 0xc0135761
    v_fmaak_f32 v162, v162, v8, 0xc0135761
    v_fmaak_f32 v163, v163, v8, 0xc0135761
    v_mul_f32 v160, v160, v16
    v_mul_f32 v161, v161, v17
    v_mul_f32 v162, v162, v18
    v_mul_f32 v163, v163, v19
    v_exp_f32 v160, v160
    v_exp_f32 v161, v161
    v_exp_f32 v162, v162
    v_exp_f32 v163, v163
    v_add_f32 v160, 1.0, v160
    v_add_f32 v161, 1.0, v161
    v_add_f32 v162, 1.0, v162
    v_add_f32 v163, 1.0, v163
    v_rcp_f32 v160, v160
    v_rcp_f32 v161, v161
    v_rcp_f32 v162, v162
    v_rcp_f32 v163, v163
    v_mul_f32 v160, v160, v16
    v_mul_f32 v161, v161, v17
    v_mul_f32 v162, v162, v18
    v_mul_f32 v163, v163, v19
    v_cvt_pk_bf16_f32 v176, v160, v161
    v_cvt_pk_bf16_f32 v177, v162, v163
    s_waitcnt lgkmcnt(8)
    v_pk_add_f32 v[20:21], v[20:21], v[36:37]
    v_pk_add_f32 v[22:23], v[22:23], v[38:39]
    s_waitcnt lgkmcnt(7)
    v_pk_add_f32 v[20:21], v[20:21], v[52:53]
    v_pk_add_f32 v[22:23], v[22:23], v[54:55]
    s_waitcnt lgkmcnt(6)
    v_pk_add_f32 v[20:21], v[20:21], v[68:69]
    v_pk_add_f32 v[22:23], v[22:23], v[70:71]
    v_mul_f32 v164, v20, v20
    v_mul_f32 v165, v21, v21
    v_mul_f32 v166, v22, v22
    v_mul_f32 v167, v23, v23
    v_fmaak_f32 v164, v164, v8, 0xc0135761
    v_fmaak_f32 v165, v165, v8, 0xc0135761
    v_fmaak_f32 v166, v166, v8, 0xc0135761
    v_fmaak_f32 v167, v167, v8, 0xc0135761
    v_mul_f32 v164, v164, v20
    v_mul_f32 v165, v165, v21
    v_mul_f32 v166, v166, v22
    v_mul_f32 v167, v167, v23
    v_exp_f32 v164, v164
    v_exp_f32 v165, v165
    v_exp_f32 v166, v166
    v_exp_f32 v167, v167
    v_add_f32 v164, 1.0, v164
    v_add_f32 v165, 1.0, v165
    v_add_f32 v166, 1.0, v166
    v_add_f32 v167, 1.0, v167
    v_rcp_f32 v164, v164
    v_rcp_f32 v165, v165
    v_rcp_f32 v166, v166
    v_rcp_f32 v167, v167
    v_mul_f32 v164, v164, v20
    v_mul_f32 v165, v165, v21
    v_mul_f32 v166, v166, v22
    v_mul_f32 v167, v167, v23
    v_cvt_pk_bf16_f32 v178, v164, v165
    v_cvt_pk_bf16_f32 v179, v166, v167
    buffer_store_dwordx4 v[176:179], v2, s[32:35], s52 offen offset:0 sc1
    s_waitcnt lgkmcnt(5)
    v_pk_add_f32 v[24:25], v[24:25], v[40:41]
    v_pk_add_f32 v[26:27], v[26:27], v[42:43]
    s_waitcnt lgkmcnt(4)
    v_pk_add_f32 v[24:25], v[24:25], v[56:57]
    v_pk_add_f32 v[26:27], v[26:27], v[58:59]
    s_waitcnt lgkmcnt(3)
    v_pk_add_f32 v[24:25], v[24:25], v[72:73]
    v_pk_add_f32 v[26:27], v[26:27], v[74:75]
    v_mul_f32 v168, v24, v24
    v_mul_f32 v169, v25, v25
    v_mul_f32 v170, v26, v26
    v_mul_f32 v171, v27, v27
    v_fmaak_f32 v168, v168, v8, 0xc0135761
    v_fmaak_f32 v169, v169, v8, 0xc0135761
    v_fmaak_f32 v170, v170, v8, 0xc0135761
    v_fmaak_f32 v171, v171, v8, 0xc0135761
    v_mul_f32 v168, v168, v24
    v_mul_f32 v169, v169, v25
    v_mul_f32 v170, v170, v26
    v_mul_f32 v171, v171, v27
    v_exp_f32 v168, v168
    v_exp_f32 v169, v169
    v_exp_f32 v170, v170
    v_exp_f32 v171, v171
    v_add_f32 v168, 1.0, v168
    v_add_f32 v169, 1.0, v169
    v_add_f32 v170, 1.0, v170
    v_add_f32 v171, 1.0, v171
    v_rcp_f32 v168, v168
    v_rcp_f32 v169, v169
    v_rcp_f32 v170, v170
    v_rcp_f32 v171, v171
    v_mul_f32 v168, v168, v24
    v_mul_f32 v169, v169, v25
    v_mul_f32 v170, v170, v26
    v_mul_f32 v171, v171, v27
    v_cvt_pk_bf16_f32 v180, v168, v169
    v_cvt_pk_bf16_f32 v181, v170, v171
    s_waitcnt lgkmcnt(2)
    v_pk_add_f32 v[28:29], v[28:29], v[44:45]
    v_pk_add_f32 v[30:31], v[30:31], v[46:47]
    s_waitcnt lgkmcnt(1)
    v_pk_add_f32 v[28:29], v[28:29], v[60:61]
    v_pk_add_f32 v[30:31], v[30:31], v[62:63]
    s_waitcnt lgkmcnt(0)
    v_pk_add_f32 v[28:29], v[28:29], v[76:77]
    v_pk_add_f32 v[30:31], v[30:31], v[78:79]
    v_mul_f32 v172, v28, v28
    v_mul_f32 v173, v29, v29
    v_mul_f32 v174, v30, v30
    v_mul_f32 v175, v31, v31
    v_fmaak_f32 v172, v172, v8, 0xc0135761
    v_fmaak_f32 v173, v173, v8, 0xc0135761
    v_fmaak_f32 v174, v174, v8, 0xc0135761
    v_fmaak_f32 v175, v175, v8, 0xc0135761
    v_mul_f32 v172, v172, v28
    v_mul_f32 v173, v173, v29
    v_mul_f32 v174, v174, v30
    v_mul_f32 v175, v175, v31
    v_exp_f32 v172, v172
    v_exp_f32 v173, v173
    v_exp_f32 v174, v174
    v_exp_f32 v175, v175
    v_add_f32 v172, 1.0, v172
    v_add_f32 v173, 1.0, v173
    v_add_f32 v174, 1.0, v174
    v_add_f32 v175, 1.0, v175
    v_rcp_f32 v172, v172
    v_rcp_f32 v173, v173
    v_rcp_f32 v174, v174
    v_rcp_f32 v175, v175
    v_mul_f32 v172, v172, v28
    v_mul_f32 v173, v173, v29
    v_mul_f32 v174, v174, v30
    v_mul_f32 v175, v175, v31
    v_cvt_pk_bf16_f32 v182, v172, v173
    v_cvt_pk_bf16_f32 v183, v174, v175
    buffer_store_dwordx4 v[180:183], v2, s[32:35], s52 offen offset:1024 sc1
    s_mul_i32 s66, s22, 14336
    s_mul_i32 s50, s3, 3584
    s_add_u32 s66, s66, s50
    s_add_u32 s66, s66, 1441792
    v_and_b32 v6, 31, v1
    v_min_u32 v6, 27, v6
    v_lshlrev_b32 v6, 7, v6
    s_waitcnt vmcnt(28)
    ds_read_b64_tr_b16 a[0:1], v240 offset:0
    ds_read_b64_tr_b16 a[2:3], v240 offset:1024
    ds_read_b64_tr_b16 a[4:5], v241 offset:0
    ds_read_b64_tr_b16 a[6:7], v241 offset:1024
    s_waitcnt vmcnt(26)
    ds_read_b64_tr_b16 a[8:9], v240 offset:2048
    ds_read_b64_tr_b16 a[10:11], v240 offset:3072
    ds_read_b64_tr_b16 a[12:13], v241 offset:2048
    ds_read_b64_tr_b16 a[14:15], v241 offset:3072
    s_waitcnt vmcnt(24)
    ds_read_b64_tr_b16 a[16:17], v240 offset:4096
    ds_read_b64_tr_b16 a[18:19], v240 offset:5120
    ds_read_b64_tr_b16 a[20:21], v241 offset:4096
    ds_read_b64_tr_b16 a[22:23], v241 offset:5120
    s_waitcnt vmcnt(22)
    ds_read_b64_tr_b16 a[24:25], v240 offset:6144
    ds_read_b64_tr_b16 a[26:27], v240 offset:7168
    ds_read_b64_tr_b16 a[28:29], v241 offset:6144
    ds_read_b64_tr_b16 a[30:31], v241 offset:7168
    s_waitcnt vmcnt(20)
    ds_read_b64_tr_b16 a[32:33], v240 offset:8192
    ds_read_b64_tr_b16 a[34:35], v240 offset:9216
    ds_read_b64_tr_b16 a[36:37], v241 offset:8192
    ds_read_b64_tr_b16 a[38:39], v241 offset:9216
    s_waitcnt vmcnt(18)
    ds_read_b64_tr_b16 a[40:41], v240 offset:10240
    ds_read_b64_tr_b16 a[42:43], v240 offset:11264
    ds_read_b64_tr_b16 a[44:45], v241 offset:10240
    ds_read_b64_tr_b16 a[46:47], v241 offset:11264
    s_waitcnt vmcnt(16)
    ds_read_b64_tr_b16 a[48:49], v240 offset:12288
    ds_read_b64_tr_b16 a[50:51], v240 offset:13312
    ds_read_b64_tr_b16 a[52:53], v241 offset:12288
    ds_read_b64_tr_b16 a[54:55], v241 offset:13312
    s_waitcnt vmcnt(14)
    ds_read_b64_tr_b16 a[56:57], v240 offset:14336
    ds_read_b64_tr_b16 a[58:59], v240 offset:15360
    ds_read_b64_tr_b16 a[60:61], v241 offset:14336
    ds_read_b64_tr_b16 a[62:63], v241 offset:15360
    s_waitcnt lgkmcnt(0)
    s_add_u32 m0, s96, 0
    s_mov_b32 s48, 917504
    buffer_load_dwordx4 v244, s[44:47], s48 offen lds
    buffer_load_dwordx4 v245, s[44:47], s48 offen offset:1024 lds
    s_add_u32 m0, s96, 2048
    s_mov_b32 s48, 983040
    buffer_load_dwordx4 v244, s[44:47], s48 offen lds
    buffer_load_dwordx4 v245, s[44:47], s48 offen offset:1024 lds
    s_add_u32 m0, s96, 4096
    s_mov_b32 s48, 1048576
    buffer_load_dwordx4 v244, s[44:47], s48 offen lds
    buffer_load_dwordx4 v245, s[44:47], s48 offen offset:1024 lds
    s_add_u32 m0, s96, 6144
    s_mov_b32 s48, 1114112
    buffer_load_dwordx4 v244, s[44:47], s48 offen lds
    buffer_load_dwordx4 v245, s[44:47], s48 offen offset:1024 lds
    s_add_u32 m0, s96, 8192
    s_mov_b32 s48, 1179648
    buffer_load_dwordx4 v244, s[44:47], s48 offen lds
    buffer_load_dwordx4 v245, s[44:47], s48 offen offset:1024 lds
    s_waitcnt vmcnt(22)
    ds_read_b64_tr_b16 a[64:65], v240 offset:16384
    ds_read_b64_tr_b16 a[66:67], v240 offset:17408
    ds_read_b64_tr_b16 a[68:69], v241 offset:16384
    ds_read_b64_tr_b16 a[70:71], v241 offset:17408
    s_waitcnt vmcnt(20)
    ds_read_b64_tr_b16 a[72:73], v240 offset:18432
    ds_read_b64_tr_b16 a[74:75], v240 offset:19456
    ds_read_b64_tr_b16 a[76:77], v241 offset:18432
    ds_read_b64_tr_b16 a[78:79], v241 offset:19456
    s_waitcnt vmcnt(18)
    ds_read_b64_tr_b16 a[80:81], v240 offset:20480
    ds_read_b64_tr_b16 a[82:83], v240 offset:21504
    ds_read_b64_tr_b16 a[84:85], v241 offset:20480
    ds_read_b64_tr_b16 a[86:87], v241 offset:21504
    s_waitcnt vmcnt(16)
    ds_read_b64_tr_b16 a[88:89], v240 offset:22528
    ds_read_b64_tr_b16 a[90:91], v240 offset:23552
    ds_read_b64_tr_b16 a[92:93], v241 offset:22528
    ds_read_b64_tr_b16 a[94:95], v241 offset:23552
    s_waitcnt vmcnt(14)
    ds_read_b64_tr_b16 a[96:97], v240 offset:24576
    ds_read_b64_tr_b16 a[98:99], v240 offset:25600
    ds_read_b64_tr_b16 a[100:101], v241 offset:24576
    ds_read_b64_tr_b16 a[102:103], v241 offset:25600
    s_waitcnt vmcnt(12)
    ds_read_b64_tr_b16 a[104:105], v240 offset:26624
    ds_read_b64_tr_b16 a[106:107], v240 offset:27648
    ds_read_b64_tr_b16 a[108:109], v241 offset:26624
    ds_read_b64_tr_b16 a[110:111], v241 offset:27648
    s_waitcnt vmcnt(10)
    v_mov_b32 v3, s26
    v_mov_b32 v4, 0
    s_mov_b64 exec, 1
    buffer_store_dword v3, v4, s[32:35], s57 offen sc1
    s_mov_b64 exec, -1
    s_waitcnt lgkmcnt(0)
    s_add_u32 m0, s96, 10240
    s_mov_b32 s48, 1245184
    buffer_load_dwordx4 v244, s[44:47], s48 offen lds
    buffer_load_dwordx4 v245, s[44:47], s48 offen offset:1024 lds
    s_add_u32 m0, s96, 12288
    s_mov_b32 s48, 1310720
    buffer_load_dwordx4 v244, s[44:47], s48 offen lds
    buffer_load_dwordx4 v245, s[44:47], s48 offen offset:1024 lds
    s_add_u32 m0, s96, 14336
    s_mov_b32 s48, 1376256
    buffer_load_dwordx4 v244, s[44:47], s48 offen lds
    buffer_load_dwordx4 v245, s[44:47], s48 offen offset:1024 lds
    s_add_u32 m0, s96, 16384
    s_mov_b32 s48, 1441792
    buffer_load_dwordx4 v244, s[44:47], s48 offen lds
    buffer_load_dwordx4 v245, s[44:47], s48 offen offset:1024 lds
    s_add_u32 m0, s96, 18432
    s_mov_b32 s48, 1507328
    buffer_load_dwordx4 v244, s[44:47], s48 offen lds
    buffer_load_dwordx4 v245, s[44:47], s48 offen offset:1024 lds
    s_add_u32 m0, s96, 20480
    s_mov_b32 s48, 1572864
    buffer_load_dwordx4 v244, s[44:47], s48 offen lds
    buffer_load_dwordx4 v245, s[44:47], s48 offen offset:1024 lds
    s_add_u32 m0, s96, 22528
    s_mov_b32 s48, 1638400
    buffer_load_dwordx4 v244, s[44:47], s48 offen lds
    buffer_load_dwordx4 v245, s[44:47], s48 offen offset:1024 lds
    s_add_u32 m0, s96, 24576
    s_mov_b32 s48, 1703936
    buffer_load_dwordx4 v244, s[44:47], s48 offen lds
    buffer_load_dwordx4 v245, s[44:47], s48 offen offset:1024 lds
    s_add_u32 m0, s96, 26624
    s_mov_b32 s48, 1769472
    buffer_load_dwordx4 v244, s[44:47], s48 offen lds
    buffer_load_dwordx4 v245, s[44:47], s48 offen offset:1024 lds
    s_barrier
sequential_preLN__sliding_block__mixer_token_mlp__prompt_kernel_joinE3:
    s_mul_i32 s51, s22, 229376
    s_mul_i32 s52, s3, 28672
    s_add_u32 s51, s51, s52
    s_add_u32 s51, s51, 12582912
    s_add_u32 s40, s24, s51
    s_addc_u32 s41, s25, 0
    s_mov_b32 s42, 229376
    s_mov_b32 s43, 0x20000
    s_mov_b32 s36, s20
    s_mov_b32 s37, s21
    s_mov_b32 s38, 1835008
    s_mov_b32 s39, 0x20000
    s_lshr_b32 s56, s3, 1
    s_mul_i32 s50, s56, 114688
    s_xor_b32 s51, s56, 1
    s_mul_i32 s51, s51, 114688
    v_add_u32 v242, s50, v2
    v_add_u32 v243, s51, v2
    s_lshl_b32 s64, s67, 1
    s_add_u32 s64, s64, s55
    s_lshl_b32 s65, s22, 1
    s_add_u32 s65, s65, s56
    s_mul_i32 s57, s64, 14
    s_add_u32 s57, s57, s65
    s_lshl_b32 s57, s57, 11
    s_add_u32 s57, s57, 8388608
    s_mov_b32 s98, 0
    s_mov_b32 s58, 0xfffffff
    s_mov_b32 s59, 0
sequential_preLN__sliding_block__mixer_token_mlp__prompt_kernel_poll43:
    s_mov_b64 exec, s[58:59]
    buffer_load_dword v3, v6, s[32:35], s66 offen sc1
    s_waitcnt vmcnt(0)
    v_cmp_ne_u32 s[58:59], s26, v3
    s_ff1_i32_b32 s99, s58
    s_cmp_lt_i32 s99, 0
    s_cbranch_scc1 sequential_preLN__sliding_block__mixer_token_mlp__prompt_kernel_got45
    s_lshl_b64 exec, 1, s99
    s_andn2_b64 s[58:59], s[58:59], exec
sequential_preLN__sliding_block__mixer_token_mlp__prompt_kernel_one44:
    buffer_load_dword v3, v6, s[32:35], s66 offen sc1
    s_add_u32 s98, s98, 1
    s_waitcnt vmcnt(0)
    v_cmp_ne_u32 vcc, s26, v3
    s_cmp_gt_u32 s98, 30000
    s_cbranch_scc1 sequential_preLN__sliding_block__mixer_token_mlp__prompt_kernel_got45
    s_cbranch_vccnz sequential_preLN__sliding_block__mixer_token_mlp__prompt_kernel_one44
    s_cmp_lg_u32 s58, 0
    s_cbranch_scc1 sequential_preLN__sliding_block__mixer_token_mlp__prompt_kernel_poll43
sequential_preLN__sliding_block__mixer_token_mlp__prompt_kernel_got45:
    s_mov_b64 exec, -1
    s_movk_i32 s49, 0
    buffer_load_dwordx4 v[80:83], v242, s[40:43], s49 offen offset:0 sc1
    buffer_load_dwordx4 v[84:87], v243, s[40:43], s49 offen offset:0 sc1
    buffer_load_dwordx4 v[88:91], v242, s[40:43], s49 offen offset:1024 sc1
    buffer_load_dwordx4 v[92:95], v243, s[40:43], s49 offen offset:1024 sc1
    buffer_load_dwordx4 v[96:99], v242, s[40:43], s49 offen offset:2048 sc1
    buffer_load_dwordx4 v[100:103], v243, s[40:43], s49 offen offset:2048 sc1
    buffer_load_dwordx4 v[104:107], v242, s[40:43], s49 offen offset:3072 sc1
    buffer_load_dwordx4 v[108:111], v243, s[40:43], s49 offen offset:3072 sc1
    s_movk_i32 s49, 4096
    buffer_load_dwordx4 v[112:115], v242, s[40:43], s49 offen offset:0 sc1
    buffer_load_dwordx4 v[116:119], v243, s[40:43], s49 offen offset:0 sc1
    buffer_load_dwordx4 v[120:123], v242, s[40:43], s49 offen offset:1024 sc1
    buffer_load_dwordx4 v[124:127], v243, s[40:43], s49 offen offset:1024 sc1
    buffer_load_dwordx4 v[8:11], v2, s[32:35], s57 offen sc1
    buffer_load_dwordx4 v[12:15], v2, s[32:35], s57 offen offset:1024 sc1
    s_waitcnt vmcnt(12)
    v_mfma_f32_32x32x16_bf16 v[16:31], v[80:83], a[0:3], 0
    v_mfma_f32_32x32x16_bf16 v[32:47], v[80:83], a[4:7], 0
    v_mfma_f32_32x32x16_bf16 v[48:63], v[84:87], a[0:3], 0
    v_mfma_f32_32x32x16_bf16 v[64:79], v[84:87], a[4:7], 0
    buffer_load_dwordx4 v[80:83], v242, s[40:43], s49 offen offset:2048 sc1
    buffer_load_dwordx4 v[84:87], v243, s[40:43], s49 offen offset:2048 sc1
    ds_read_b64_tr_b16 a[112:113], v240 offset:0
    ds_read_b64_tr_b16 a[114:115], v240 offset:1024
    ds_read_b64_tr_b16 a[116:117], v241 offset:0
    ds_read_b64_tr_b16 a[118:119], v241 offset:1024
    s_waitcnt vmcnt(12)
    v_mfma_f32_32x32x16_bf16 v[16:31], v[88:91], a[8:11], v[16:31]
    v_mfma_f32_32x32x16_bf16 v[32:47], v[88:91], a[12:15], v[32:47]
    v_mfma_f32_32x32x16_bf16 v[48:63], v[92:95], a[8:11], v[48:63]
    v_mfma_f32_32x32x16_bf16 v[64:79], v[92:95], a[12:15], v[64:79]
    buffer_load_dwordx4 v[88:91], v242, s[40:43], s49 offen offset:3072 sc1
    buffer_load_dwordx4 v[92:95], v243, s[40:43], s49 offen offset:3072 sc1
    ds_read_b64_tr_b16 a[120:121], v240 offset:2048
    ds_read_b64_tr_b16 a[122:123], v240 offset:3072
    ds_read_b64_tr_b16 a[124:125], v241 offset:2048
    ds_read_b64_tr_b16 a[126:127], v241 offset:3072
    s_waitcnt vmcnt(12)
    v_mfma_f32_32x32x16_bf16 v[16:31], v[96:99], a[16:19], v[16:31]
    v_mfma_f32_32x32x16_bf16 v[32:47], v[96:99], a[20:23], v[32:47]
    v_mfma_f32_32x32x16_bf16 v[48:63], v[100:103], a[16:19], v[48:63]
    v_mfma_f32_32x32x16_bf16 v[64:79], v[100:103], a[20:23], v[64:79]
    s_movk_i32 s49, 8192
    buffer_load_dwordx4 v[96:99], v242, s[40:43], s49 offen offset:0 sc1
    buffer_load_dwordx4 v[100:103], v243, s[40:43], s49 offen offset:0 sc1
    ds_read_b64_tr_b16 a[128:129], v240 offset:4096
    ds_read_b64_tr_b16 a[130:131], v240 offset:5120
    ds_read_b64_tr_b16 a[132:133], v241 offset:4096
    ds_read_b64_tr_b16 a[134:135], v241 offset:5120
    s_waitcnt vmcnt(12)
    v_mfma_f32_32x32x16_bf16 v[16:31], v[104:107], a[24:27], v[16:31]
    v_mfma_f32_32x32x16_bf16 v[32:47], v[104:107], a[28:31], v[32:47]
    v_mfma_f32_32x32x16_bf16 v[48:63], v[108:111], a[24:27], v[48:63]
    v_mfma_f32_32x32x16_bf16 v[64:79], v[108:111], a[28:31], v[64:79]
    buffer_load_dwordx4 v[104:107], v242, s[40:43], s49 offen offset:1024 sc1
    buffer_load_dwordx4 v[108:111], v243, s[40:43], s49 offen offset:1024 sc1
    ds_read_b64_tr_b16 a[136:137], v240 offset:6144
    ds_read_b64_tr_b16 a[138:139], v240 offset:7168
    ds_read_b64_tr_b16 a[140:141], v241 offset:6144
    ds_read_b64_tr_b16 a[142:143], v241 offset:7168
    s_waitcnt vmcnt(12)
    v_mfma_f32_32x32x16_bf16 v[16:31], v[112:115], a[32:35], v[16:31]
    v_mfma_f32_32x32x16_bf16 v[32:47], v[112:115], a[36:39], v[32:47]
    v_mfma_f32_32x32x16_bf16 v[48:63], v[116:119], a[32:35], v[48:63]
    v_mfma_f32_32x32x16_bf16 v[64:79], v[116:119], a[36:39], v[64:79]
    buffer_load_dwordx4 v[112:115], v242, s[40:43], s49 offen offset:2048 sc1
    buffer_load_dwordx4 v[116:119], v243, s[40:43], s49 offen offset:2048 sc1
    ds_read_b64_tr_b16 a[144:145], v240 offset:8192
    ds_read_b64_tr_b16 a[146:147], v240 offset:9216
    ds_read_b64_tr_b16 a[148:149], v241 offset:8192
    ds_read_b64_tr_b16 a[150:151], v241 offset:9216
    s_waitcnt vmcnt(12)
    v_mfma_f32_32x32x16_bf16 v[16:31], v[120:123], a[40:43], v[16:31]
    v_mfma_f32_32x32x16_bf16 v[32:47], v[120:123], a[44:47], v[32:47]
    v_mfma_f32_32x32x16_bf16 v[48:63], v[124:127], a[40:43], v[48:63]
    v_mfma_f32_32x32x16_bf16 v[64:79], v[124:127], a[44:47], v[64:79]
    buffer_load_dwordx4 v[120:123], v242, s[40:43], s49 offen offset:3072 sc1
    buffer_load_dwordx4 v[124:127], v243, s[40:43], s49 offen offset:3072 sc1
    ds_read_b64_tr_b16 a[152:153], v240 offset:10240
    ds_read_b64_tr_b16 a[154:155], v240 offset:11264
    ds_read_b64_tr_b16 a[156:157], v241 offset:10240
    ds_read_b64_tr_b16 a[158:159], v241 offset:11264
    s_waitcnt vmcnt(10)
    v_mfma_f32_32x32x16_bf16 v[16:31], v[80:83], a[48:51], v[16:31]
    v_mfma_f32_32x32x16_bf16 v[32:47], v[80:83], a[52:55], v[32:47]
    v_mfma_f32_32x32x16_bf16 v[48:63], v[84:87], a[48:51], v[48:63]
    v_mfma_f32_32x32x16_bf16 v[64:79], v[84:87], a[52:55], v[64:79]
    s_movk_i32 s49, 12288
    buffer_load_dwordx4 v[80:83], v242, s[40:43], s49 offen offset:0 sc1
    buffer_load_dwordx4 v[84:87], v243, s[40:43], s49 offen offset:0 sc1
    ds_read_b64_tr_b16 a[160:161], v240 offset:12288
    ds_read_b64_tr_b16 a[162:163], v240 offset:13312
    ds_read_b64_tr_b16 a[164:165], v241 offset:12288
    ds_read_b64_tr_b16 a[166:167], v241 offset:13312
    s_waitcnt vmcnt(10)
    v_mfma_f32_32x32x16_bf16 v[16:31], v[88:91], a[56:59], v[16:31]
    v_mfma_f32_32x32x16_bf16 v[32:47], v[88:91], a[60:63], v[32:47]
    v_mfma_f32_32x32x16_bf16 v[48:63], v[92:95], a[56:59], v[48:63]
    v_mfma_f32_32x32x16_bf16 v[64:79], v[92:95], a[60:63], v[64:79]
    buffer_load_dwordx4 v[88:91], v242, s[40:43], s49 offen offset:1024 sc1
    buffer_load_dwordx4 v[92:95], v243, s[40:43], s49 offen offset:1024 sc1
    ds_read_b64_tr_b16 a[168:169], v240 offset:14336
    ds_read_b64_tr_b16 a[170:171], v240 offset:15360
    ds_read_b64_tr_b16 a[172:173], v241 offset:14336
    ds_read_b64_tr_b16 a[174:175], v241 offset:15360
    s_waitcnt vmcnt(10)
    v_mfma_f32_32x32x16_bf16 v[16:31], v[96:99], a[64:67], v[16:31]
    v_mfma_f32_32x32x16_bf16 v[32:47], v[96:99], a[68:71], v[32:47]
    v_mfma_f32_32x32x16_bf16 v[48:63], v[100:103], a[64:67], v[48:63]
    v_mfma_f32_32x32x16_bf16 v[64:79], v[100:103], a[68:71], v[64:79]
    buffer_load_dwordx4 v[96:99], v242, s[40:43], s49 offen offset:2048 sc1
    buffer_load_dwordx4 v[100:103], v243, s[40:43], s49 offen offset:2048 sc1
    ds_read_b64_tr_b16 a[176:177], v240 offset:16384
    ds_read_b64_tr_b16 a[178:179], v240 offset:17408
    ds_read_b64_tr_b16 a[180:181], v241 offset:16384
    ds_read_b64_tr_b16 a[182:183], v241 offset:17408
    s_waitcnt vmcnt(10)
    v_mfma_f32_32x32x16_bf16 v[16:31], v[104:107], a[72:75], v[16:31]
    v_mfma_f32_32x32x16_bf16 v[32:47], v[104:107], a[76:79], v[32:47]
    v_mfma_f32_32x32x16_bf16 v[48:63], v[108:111], a[72:75], v[48:63]
    v_mfma_f32_32x32x16_bf16 v[64:79], v[108:111], a[76:79], v[64:79]
    buffer_load_dwordx4 v[104:107], v242, s[40:43], s49 offen offset:3072 sc1
    buffer_load_dwordx4 v[108:111], v243, s[40:43], s49 offen offset:3072 sc1
    ds_read_b64_tr_b16 a[184:185], v240 offset:18432
    ds_read_b64_tr_b16 a[186:187], v240 offset:19456
    ds_read_b64_tr_b16 a[188:189], v241 offset:18432
    ds_read_b64_tr_b16 a[190:191], v241 offset:19456
    s_waitcnt vmcnt(10)
    v_mfma_f32_32x32x16_bf16 v[16:31], v[112:115], a[80:83], v[16:31]
    v_mfma_f32_32x32x16_bf16 v[32:47], v[112:115], a[84:87], v[32:47]
    v_mfma_f32_32x32x16_bf16 v[48:63], v[116:119], a[80:83], v[48:63]
    v_mfma_f32_32x32x16_bf16 v[64:79], v[116:119], a[84:87], v[64:79]
    s_movk_i32 s49, 16384
    buffer_load_dwordx4 v[112:115], v242, s[40:43], s49 offen offset:0 sc1
    buffer_load_dwordx4 v[116:119], v243, s[40:43], s49 offen offset:0 sc1
    ds_read_b64_tr_b16 a[192:193], v240 offset:20480
    ds_read_b64_tr_b16 a[194:195], v240 offset:21504
    ds_read_b64_tr_b16 a[196:197], v241 offset:20480
    ds_read_b64_tr_b16 a[198:199], v241 offset:21504
    s_waitcnt vmcnt(10)
    v_mfma_f32_32x32x16_bf16 v[16:31], v[120:123], a[88:91], v[16:31]
    v_mfma_f32_32x32x16_bf16 v[32:47], v[120:123], a[92:95], v[32:47]
    v_mfma_f32_32x32x16_bf16 v[48:63], v[124:127], a[88:91], v[48:63]
    v_mfma_f32_32x32x16_bf16 v[64:79], v[124:127], a[92:95], v[64:79]
    buffer_load_dwordx4 v[120:123], v242, s[40:43], s49 offen offset:1024 sc1
    buffer_load_dwordx4 v[124:127], v243, s[40:43], s49 offen offset:1024 sc1
    ds_read_b64_tr_b16 a[200:201], v240 offset:22528
    ds_read_b64_tr_b16 a[202:203], v240 offset:23552
    ds_read_b64_tr_b16 a[204:205], v241 offset:22528
    ds_read_b64_tr_b16 a[206:207], v241 offset:23552
    s_waitcnt vmcnt(10)
    v_mfma_f32_32x32x16_bf16 v[16:31], v[80:83], a[96:99], v[16:31]
    v_mfma_f32_32x32x16_bf16 v[32:47], v[80:83], a[100:103], v[32:47]
    v_mfma_f32_32x32x16_bf16 v[48:63], v[84:87], a[96:99], v[48:63]
    v_mfma_f32_32x32x16_bf16 v[64:79], v[84:87], a[100:103], v[64:79]
    buffer_load_dwordx4 v[80:83], v242, s[40:43], s49 offen offset:2048 sc1
    buffer_load_dwordx4 v[84:87], v243, s[40:43], s49 offen offset:2048 sc1
    ds_read_b64_tr_b16 a[208:209], v240 offset:24576
    ds_read_b64_tr_b16 a[210:211], v240 offset:25600
    ds_read_b64_tr_b16 a[212:213], v241 offset:24576
    ds_read_b64_tr_b16 a[214:215], v241 offset:25600
    s_waitcnt vmcnt(10)
    v_mfma_f32_32x32x16_bf16 v[16:31], v[88:91], a[104:107], v[16:31]
    v_mfma_f32_32x32x16_bf16 v[32:47], v[88:91], a[108:111], v[32:47]
    v_mfma_f32_32x32x16_bf16 v[48:63], v[92:95], a[104:107], v[48:63]
    v_mfma_f32_32x32x16_bf16 v[64:79], v[92:95], a[108:111], v[64:79]
    buffer_load_dwordx4 v[88:91], v242, s[40:43], s49 offen offset:3072 sc1
    buffer_load_dwordx4 v[92:95], v243, s[40:43], s49 offen offset:3072 sc1
    ds_read_b64_tr_b16 a[216:217], v240 offset:26624
    ds_read_b64_tr_b16 a[218:219], v240 offset:27648
    ds_read_b64_tr_b16 a[220:221], v241 offset:26624
    ds_read_b64_tr_b16 a[222:223], v241 offset:27648
    s_waitcnt vmcnt(10)
    s_waitcnt lgkmcnt(15)
    v_mfma_f32_32x32x16_bf16 v[16:31], v[96:99], a[112:115], v[16:31]
    v_mfma_f32_32x32x16_bf16 v[32:47], v[96:99], a[116:119], v[32:47]
    v_mfma_f32_32x32x16_bf16 v[48:63], v[100:103], a[112:115], v[48:63]
    v_mfma_f32_32x32x16_bf16 v[64:79], v[100:103], a[116:119], v[64:79]
    s_movk_i32 s49, 20480
    buffer_load_dwordx4 v[96:99], v242, s[40:43], s49 offen offset:0 sc1
    buffer_load_dwordx4 v[100:103], v243, s[40:43], s49 offen offset:0 sc1
    s_waitcnt vmcnt(10)
    v_mfma_f32_32x32x16_bf16 v[16:31], v[104:107], a[120:123], v[16:31]
    v_mfma_f32_32x32x16_bf16 v[32:47], v[104:107], a[124:127], v[32:47]
    v_mfma_f32_32x32x16_bf16 v[48:63], v[108:111], a[120:123], v[48:63]
    v_mfma_f32_32x32x16_bf16 v[64:79], v[108:111], a[124:127], v[64:79]
    buffer_load_dwordx4 v[104:107], v242, s[40:43], s49 offen offset:1024 sc1
    buffer_load_dwordx4 v[108:111], v243, s[40:43], s49 offen offset:1024 sc1
    s_waitcnt vmcnt(10)
    v_mfma_f32_32x32x16_bf16 v[16:31], v[112:115], a[128:131], v[16:31]
    v_mfma_f32_32x32x16_bf16 v[32:47], v[112:115], a[132:135], v[32:47]
    v_mfma_f32_32x32x16_bf16 v[48:63], v[116:119], a[128:131], v[48:63]
    v_mfma_f32_32x32x16_bf16 v[64:79], v[116:119], a[132:135], v[64:79]
    buffer_load_dwordx4 v[112:115], v242, s[40:43], s49 offen offset:2048 sc1
    buffer_load_dwordx4 v[116:119], v243, s[40:43], s49 offen offset:2048 sc1
    s_waitcnt vmcnt(10)
    v_mfma_f32_32x32x16_bf16 v[16:31], v[120:123], a[136:139], v[16:31]
    v_mfma_f32_32x32x16_bf16 v[32:47], v[120:123], a[140:143], v[32:47]
    v_mfma_f32_32x32x16_bf16 v[48:63], v[124:127], a[136:139], v[48:63]
    v_mfma_f32_32x32x16_bf16 v[64:79], v[124:127], a[140:143], v[64:79]
    buffer_load_dwordx4 v[120:123], v242, s[40:43], s49 offen offset:3072 sc1
    buffer_load_dwordx4 v[124:127], v243, s[40:43], s49 offen offset:3072 sc1
    s_waitcnt vmcnt(10)
    v_mfma_f32_32x32x16_bf16 v[16:31], v[80:83], a[144:147], v[16:31]
    v_mfma_f32_32x32x16_bf16 v[32:47], v[80:83], a[148:151], v[32:47]
    v_mfma_f32_32x32x16_bf16 v[48:63], v[84:87], a[144:147], v[48:63]
    v_mfma_f32_32x32x16_bf16 v[64:79], v[84:87], a[148:151], v[64:79]
    s_movk_i32 s49, 24576
    buffer_load_dwordx4 v[80:83], v242, s[40:43], s49 offen offset:0 sc1
    buffer_load_dwordx4 v[84:87], v243, s[40:43], s49 offen offset:0 sc1
    s_waitcnt vmcnt(10)
    v_mfma_f32_32x32x16_bf16 v[16:31], v[88:91], a[152:155], v[16:31]
    v_mfma_f32_32x32x16_bf16 v[32:47], v[88:91], a[156:159], v[32:47]
    v_mfma_f32_32x32x16_bf16 v[48:63], v[92:95], a[152:155], v[48:63]
    v_mfma_f32_32x32x16_bf16 v[64:79], v[92:95], a[156:159], v[64:79]
    buffer_load_dwordx4 v[88:91], v242, s[40:43], s49 offen offset:1024 sc1
    buffer_load_dwordx4 v[92:95], v243, s[40:43], s49 offen offset:1024 sc1
    s_waitcnt vmcnt(10)
    v_mfma_f32_32x32x16_bf16 v[16:31], v[96:99], a[160:163], v[16:31]
    v_mfma_f32_32x32x16_bf16 v[32:47], v[96:99], a[164:167], v[32:47]
    v_mfma_f32_32x32x16_bf16 v[48:63], v[100:103], a[160:163], v[48:63]
    v_mfma_f32_32x32x16_bf16 v[64:79], v[100:103], a[164:167], v[64:79]
    buffer_load_dwordx4 v[96:99], v242, s[40:43], s49 offen offset:2048 sc1
    buffer_load_dwordx4 v[100:103], v243, s[40:43], s49 offen offset:2048 sc1
    s_waitcnt vmcnt(10)
    v_mfma_f32_32x32x16_bf16 v[16:31], v[104:107], a[168:171], v[16:31]
    v_mfma_f32_32x32x16_bf16 v[32:47], v[104:107], a[172:175], v[32:47]
    v_mfma_f32_32x32x16_bf16 v[48:63], v[108:111], a[168:171], v[48:63]
    v_mfma_f32_32x32x16_bf16 v[64:79], v[108:111], a[172:175], v[64:79]
    buffer_load_dwordx4 v[104:107], v242, s[40:43], s49 offen offset:3072 sc1
    buffer_load_dwordx4 v[108:111], v243, s[40:43], s49 offen offset:3072 sc1
    s_waitcnt vmcnt(10)
    v_mfma_f32_32x32x16_bf16 v[16:31], v[112:115], a[176:179], v[16:31]
    v_mfma_f32_32x32x16_bf16 v[32:47], v[112:115], a[180:183], v[32:47]
    v_mfma_f32_32x32x16_bf16 v[48:63], v[116:119], a[176:179], v[48:63]
    v_mfma_f32_32x32x16_bf16 v[64:79], v[116:119], a[180:183], v[64:79]
    s_waitcnt vmcnt(8)
    v_mfma_f32_32x32x16_bf16 v[16:31], v[120:123], a[184:187], v[16:31]
    v_mfma_f32_32x32x16_bf16 v[32:47], v[120:123], a[188:191], v[32:47]
    v_mfma_f32_32x32x16_bf16 v[48:63], v[124:127], a[184:187], v[48:63]
    v_mfma_f32_32x32x16_bf16 v[64:79], v[124:127], a[188:191], v[64:79]
    s_waitcnt vmcnt(6)
    s_waitcnt lgkmcnt(12)
    v_mfma_f32_32x32x16_bf16 v[16:31], v[80:83], a[192:195], v[16:31]
    v_mfma_f32_32x32x16_bf16 v[32:47], v[80:83], a[196:199], v[32:47]
    v_mfma_f32_32x32x16_bf16 v[48:63], v[84:87], a[192:195], v[48:63]
    v_mfma_f32_32x32x16_bf16 v[64:79], v[84:87], a[196:199], v[64:79]
    s_waitcnt vmcnt(4)
    s_waitcnt lgkmcnt(8)
    v_mfma_f32_32x32x16_bf16 v[16:31], v[88:91], a[200:203], v[16:31]
    v_mfma_f32_32x32x16_bf16 v[32:47], v[88:91], a[204:207], v[32:47]
    v_mfma_f32_32x32x16_bf16 v[48:63], v[92:95], a[200:203], v[48:63]
    v_mfma_f32_32x32x16_bf16 v[64:79], v[92:95], a[204:207], v[64:79]
    s_waitcnt vmcnt(2)
    s_waitcnt lgkmcnt(4)
    v_mfma_f32_32x32x16_bf16 v[16:31], v[96:99], a[208:211], v[16:31]
    v_mfma_f32_32x32x16_bf16 v[32:47], v[96:99], a[212:215], v[32:47]
    v_mfma_f32_32x32x16_bf16 v[48:63], v[100:103], a[208:211], v[48:63]
    v_mfma_f32_32x32x16_bf16 v[64:79], v[100:103], a[212:215], v[64:79]
    s_waitcnt vmcnt(0)
    s_waitcnt lgkmcnt(0)
    v_mfma_f32_32x32x16_bf16 v[16:31], v[104:107], a[216:219], v[16:31]
    v_mfma_f32_32x32x16_bf16 v[32:47], v[104:107], a[220:223], v[32:47]
    v_mfma_f32_32x32x16_bf16 v[48:63], v[108:111], a[216:219], v[48:63]
    v_mfma_f32_32x32x16_bf16 v[64:79], v[108:111], a[220:223], v[64:79]
    s_xor_b32 s50, s3, 1
    s_mul_i32 s50, s50, 12288
    s_add_u32 s50, s50, 114688
    v_add_u32 v4, s50, v2
    s_xor_b32 s50, s3, 2
    s_mul_i32 s50, s50, 12288
    s_add_u32 s50, s50, 118784
    v_add_u32 v5, s50, v2
    s_xor_b32 s50, s3, 3
    s_mul_i32 s50, s50, 12288
    s_add_u32 s50, s50, 122880
    v_add_u32 v6, s50, v2
    s_mul_i32 s50, s3, 12288
    s_add_u32 s50, s50, 114688
    v_add_u32 v7, s50, v2
    ds_write_b128 v4, v[32:35] offset:0
    ds_write_b128 v4, v[36:39] offset:1024
    ds_write_b128 v4, v[40:43] offset:2048
    ds_write_b128 v4, v[44:47] offset:3072
    ds_write_b128 v5, v[48:51] offset:0
    ds_write_b128 v5, v[52:55] offset:1024
    ds_write_b128 v5, v[56:59] offset:2048
    ds_write_b128 v5, v[60:63] offset:3072
    ds_write_b128 v6, v[64:67] offset:0
    ds_write_b128 v6, v[68:71] offset:1024
    ds_write_b128 v6, v[72:75] offset:2048
    ds_write_b128 v6, v[76:79] offset:3072
    v_and_b32 v3, 31, v1
    v_lshrrev_b32 v160, 5, v1
    v_mul_u32_u24 v162, 896, v3
    v_lshl_add_u32 v162, v160, 4, v162
    s_mul_i32 s52, s64, 28672
    s_lshl_b32 s51, s65, 6
    s_add_u32 s52, s52, s51
    v_lshlrev_b32 v254, 16, v254
    v_lshlrev_b32 v160, 16, v8
    v_and_b32 v161, 0xffff0000, v8
    v_add_f32 v160, v160, v254
    v_add_f32 v161, v161, v254
    v_pk_add_f32 v[16:17], v[16:17], v[160:161]
    v_lshlrev_b32 v160, 16, v9
    v_and_b32 v161, 0xffff0000, v9
    v_add_f32 v160, v160, v254
    v_add_f32 v161, v161, v254
    v_pk_add_f32 v[18:19], v[18:19], v[160:161]
    v_lshlrev_b32 v160, 16, v10
    v_and_b32 v161, 0xffff0000, v10
    v_add_f32 v160, v160, v254
    v_add_f32 v161, v161, v254
    v_pk_add_f32 v[20:21], v[20:21], v[160:161]
    v_lshlrev_b32 v160, 16, v11
    v_and_b32 v161, 0xffff0000, v11
    v_add_f32 v160, v160, v254
    v_add_f32 v161, v161, v254
    v_pk_add_f32 v[22:23], v[22:23], v[160:161]
    v_lshlrev_b32 v160, 16, v12
    v_and_b32 v161, 0xffff0000, v12
    v_add_f32 v160, v160, v254
    v_add_f32 v161, v161, v254
    v_pk_add_f32 v[24:25], v[24:25], v[160:161]
    v_lshlrev_b32 v160, 16, v13
    v_and_b32 v161, 0xffff0000, v13
    v_add_f32 v160, v160, v254
    v_add_f32 v161, v161, v254
    v_pk_add_f32 v[26:27], v[26:27], v[160:161]
    v_lshlrev_b32 v160, 16, v14
    v_and_b32 v161, 0xffff0000, v14
    v_add_f32 v160, v160, v254
    v_add_f32 v161, v161, v254
    v_pk_add_f32 v[28:29], v[28:29], v[160:161]
    v_lshlrev_b32 v160, 16, v15
    v_and_b32 v161, 0xffff0000, v15
    v_add_f32 v160, v160, v254
    v_add_f32 v161, v161, v254
    v_pk_add_f32 v[30:31], v[30:31], v[160:161]
    s_waitcnt lgkmcnt(0)
    s_barrier
    ds_read_b128 v[32:35], v7 offset:0
    ds_read_b128 v[48:51], v7 offset:4096
    ds_read_b128 v[64:67], v7 offset:8192
    ds_read_b128 v[36:39], v7 offset:1024
    ds_read_b128 v[52:55], v7 offset:5120
    ds_read_b128 v[68:71], v7 offset:9216
    ds_read_b128 v[40:43], v7 offset:2048
    ds_read_b128 v[56:59], v7 offset:6144
    ds_read_b128 v[72:75], v7 offset:10240
    ds_read_b128 v[44:47], v7 offset:3072
    ds_read_b128 v[60:63], v7 offset:7168
    ds_read_b128 v[76:79], v7 offset:11264
    s_waitcnt lgkmcnt(11)
    v_pk_add_f32 v[16:17], v[16:17], v[32:33]
    v_pk_add_f32 v[18:19], v[18:19], v[34:35]
    s_waitcnt lgkmcnt(10)
    v_pk_add_f32 v[16:17], v[16:17], v[48:49]
    v_pk_add_f32 v[18:19], v[18:19], v[50:51]
    s_waitcnt lgkmcnt(9)
    v_pk_add_f32 v[16:17], v[16:17], v[64:65]
    v_pk_add_f32 v[18:19], v[18:19], v[66:67]
    v_cvt_pk_bf16_f32 v176, v16, v17
    v_cvt_pk_bf16_f32 v177, v18, v19
    s_waitcnt lgkmcnt(8)
    v_pk_add_f32 v[20:21], v[20:21], v[36:37]
    v_pk_add_f32 v[22:23], v[22:23], v[38:39]
    s_waitcnt lgkmcnt(7)
    v_pk_add_f32 v[20:21], v[20:21], v[52:53]
    v_pk_add_f32 v[22:23], v[22:23], v[54:55]
    s_waitcnt lgkmcnt(6)
    v_pk_add_f32 v[20:21], v[20:21], v[68:69]
    v_pk_add_f32 v[22:23], v[22:23], v[70:71]
    v_cvt_pk_bf16_f32 v178, v20, v21
    v_cvt_pk_bf16_f32 v179, v22, v23
    s_nop 0
    v_permlane32_swap_b32 v176, v178
    v_permlane32_swap_b32 v177, v179
    buffer_store_dwordx4 v[176:179], v162, s[36:39], s52 offen offset:0
    s_waitcnt lgkmcnt(5)
    v_pk_add_f32 v[24:25], v[24:25], v[40:41]
    v_pk_add_f32 v[26:27], v[26:27], v[42:43]
    s_waitcnt lgkmcnt(4)
    v_pk_add_f32 v[24:25], v[24:25], v[56:57]
    v_pk_add_f32 v[26:27], v[26:27], v[58:59]
    s_waitcnt lgkmcnt(3)
    v_pk_add_f32 v[24:25], v[24:25], v[72:73]
    v_pk_add_f32 v[26:27], v[26:27], v[74:75]
    v_cvt_pk_bf16_f32 v180, v24, v25
    v_cvt_pk_bf16_f32 v181, v26, v27
    s_waitcnt lgkmcnt(2)
    v_pk_add_f32 v[28:29], v[28:29], v[44:45]
    v_pk_add_f32 v[30:31], v[30:31], v[46:47]
    s_waitcnt lgkmcnt(1)
    v_pk_add_f32 v[28:29], v[28:29], v[60:61]
    v_pk_add_f32 v[30:31], v[30:31], v[62:63]
    s_waitcnt lgkmcnt(0)
    v_pk_add_f32 v[28:29], v[28:29], v[76:77]
    v_pk_add_f32 v[30:31], v[30:31], v[78:79]
    v_cvt_pk_bf16_f32 v182, v28, v29
    v_cvt_pk_bf16_f32 v183, v30, v31
    s_nop 0
    v_permlane32_swap_b32 v180, v182
    v_permlane32_swap_b32 v181, v183
    buffer_store_dwordx4 v[180:183], v162, s[36:39], s52 offen offset:32
    s_or_b32 s50, s2, s3
    s_cmp_lg_u32 s50, 0
    s_cbranch_scc1 sequential_preLN__sliding_block__mixer_token_mlp__prompt_kernel_fin4_c
    s_mov_b32 s50, 1572876
    v_mov_b32 v3, s26
    v_mov_b32 v4, 0
    s_mov_b64 exec, 1
    buffer_store_dword v3, v4, s[32:35], s50 offen sc1
    s_mov_b64 exec, -1
sequential_preLN__sliding_block__mixer_token_mlp__prompt_kernel_fin4_c:
sequential_preLN__sliding_block__mixer_token_mlp__prompt_kernel_fin4:
sequential_preLN__sliding_block__mixer_token_mlp__prompt_kernel_end:
    s_endpgm
sequential_preLN__sliding_block__mixer_token_mlp__prompt_kernel_inv12:
    v_mov_b32 v64, 0xff800000
    v_mov_b32 v65, 0xff800000
    v_mov_b32 v66, 0xff800000
    v_mov_b32 v67, 0xff800000
    v_mov_b32 v68, 0xff800000
    v_mov_b32 v69, 0xff800000
    v_mov_b32 v70, 0xff800000
    v_mov_b32 v71, 0xff800000
    v_mov_b32 v72, 0xff800000
    v_mov_b32 v73, 0xff800000
    v_mov_b32 v74, 0xff800000
    v_mov_b32 v75, 0xff800000
    v_mov_b32 v76, 0xff800000
    v_mov_b32 v77, 0xff800000
    v_mov_b32 v78, 0xff800000
    v_mov_b32 v79, 0xff800000
    s_branch sequential_preLN__sliding_block__mixer_token_mlp__prompt_kernel_back13
sequential_preLN__sliding_block__mixer_token_mlp__prompt_kernel_inv14:
    v_mov_b32 v80, 0xff800000
    v_mov_b32 v81, 0xff800000
    v_mov_b32 v82, 0xff800000
    v_mov_b32 v83, 0xff800000
    v_mov_b32 v84, 0xff800000
    v_mov_b32 v85, 0xff800000
    v_mov_b32 v86, 0xff800000
    v_mov_b32 v87, 0xff800000
    v_mov_b32 v88, 0xff800000
    v_mov_b32 v89, 0xff800000
    v_mov_b32 v90, 0xff800000
    v_mov_b32 v91, 0xff800000
    v_mov_b32 v92, 0xff800000
    v_mov_b32 v93, 0xff800000
    v_mov_b32 v94, 0xff800000
    v_mov_b32 v95, 0xff800000
    s_branch sequential_preLN__sliding_block__mixer_token_mlp__prompt_kernel_back15
sequential_preLN__sliding_block__mixer_token_mlp__prompt_kernel_inv16:
    v_mov_b32 v96, 0xff800000
    v_mov_b32 v97, 0xff800000
    v_mov_b32 v98, 0xff800000
    v_mov_b32 v99, 0xff800000
    v_mov_b32 v100, 0xff800000
    v_mov_b32 v101, 0xff800000
    v_mov_b32 v102, 0xff800000
    v_mov_b32 v103, 0xff800000
    v_mov_b32 v104, 0xff800000
    v_mov_b32 v105, 0xff800000
    v_mov_b32 v106, 0xff800000
    v_mov_b32 v107, 0xff800000
    v_mov_b32 v108, 0xff800000
    v_mov_b32 v109, 0xff800000
    v_mov_b32 v110, 0xff800000
    v_mov_b32 v111, 0xff800000
    s_branch sequential_preLN__sliding_block__mixer_token_mlp__prompt_kernel_back17
sequential_preLN__sliding_block__mixer_token_mlp__prompt_kernel_inv18:
    v_mov_b32 v112, 0xff800000
    v_mov_b32 v113, 0xff800000
    v_mov_b32 v114, 0xff800000
    v_mov_b32 v115, 0xff800000
    v_mov_b32 v116, 0xff800000
    v_mov_b32 v117, 0xff800000
    v_mov_b32 v118, 0xff800000
    v_mov_b32 v119, 0xff800000
    v_mov_b32 v120, 0xff800000
    v_mov_b32 v121, 0xff800000
    v_mov_b32 v122, 0xff800000
    v_mov_b32 v123, 0xff800000
    v_mov_b32 v124, 0xff800000
    v_mov_b32 v125, 0xff800000
    v_mov_b32 v126, 0xff800000
    v_mov_b32 v127, 0xff800000
    s_branch sequential_preLN__sliding_block__mixer_token_mlp__prompt_kernel_back19
sequential_preLN__sliding_block__mixer_token_mlp__prompt_kernel_inv20:
    v_mov_b32 v128, 0xff800000
    v_mov_b32 v129, 0xff800000
    v_mov_b32 v130, 0xff800000
    v_mov_b32 v131, 0xff800000
    v_mov_b32 v132, 0xff800000
    v_mov_b32 v133, 0xff800000
    v_mov_b32 v134, 0xff800000
    v_mov_b32 v135, 0xff800000
    v_mov_b32 v136, 0xff800000
    v_mov_b32 v137, 0xff800000
    v_mov_b32 v138, 0xff800000
    v_mov_b32 v139, 0xff800000
    v_mov_b32 v140, 0xff800000
    v_mov_b32 v141, 0xff800000
    v_mov_b32 v142, 0xff800000
    v_mov_b32 v143, 0xff800000
    s_branch sequential_preLN__sliding_block__mixer_token_mlp__prompt_kernel_back21
sequential_preLN__sliding_block__mixer_token_mlp__prompt_kernel_inv22:
    v_mov_b32 v144, 0xff800000
    v_mov_b32 v145, 0xff800000
    v_mov_b32 v146, 0xff800000
    v_mov_b32 v147, 0xff800000
    v_mov_b32 v148, 0xff800000
    v_mov_b32 v149, 0xff800000
    v_mov_b32 v150, 0xff800000
    v_mov_b32 v151, 0xff800000
    v_mov_b32 v152, 0xff800000
    v_mov_b32 v153, 0xff800000
    v_mov_b32 v154, 0xff800000
    v_mov_b32 v155, 0xff800000
    v_mov_b32 v156, 0xff800000
    v_mov_b32 v157, 0xff800000
    v_mov_b32 v158, 0xff800000
    v_mov_b32 v159, 0xff800000
    s_branch sequential_preLN__sliding_block__mixer_token_mlp__prompt_kernel_back23
sequential_preLN__sliding_block__mixer_token_mlp__prompt_kernel_inv24:
    v_mov_b32 v160, 0xff800000
    v_mov_b32 v161, 0xff800000
    v_mov_b32 v162, 0xff800000
    v_mov_b32 v163, 0xff800000
    v_mov_b32 v164, 0xff800000
    v_mov_b32 v165, 0xff800000
    v_mov_b32 v166, 0xff800000
    v_mov_b32 v167, 0xff800000
    v_mov_b32 v168, 0xff800000
    v_mov_b32 v169, 0xff800000
    v_mov_b32 v170, 0xff800000
    v_mov_b32 v171, 0xff800000
    v_mov_b32 v172, 0xff800000
    v_mov_b32 v173, 0xff800000
    v_mov_b32 v174, 0xff800000
    v_mov_b32 v175, 0xff800000
    s_branch sequential_preLN__sliding_block__mixer_token_mlp__prompt_kernel_back25
sequential_preLN__sliding_block__mixer_token_mlp__prompt_kernel_inv26:
    v_mov_b32 v176, 0xff800000
    v_mov_b32 v177, 0xff800000
    v_mov_b32 v178, 0xff800000
    v_mov_b32 v179, 0xff800000
    v_mov_b32 v180, 0xff800000
    v_mov_b32 v181, 0xff800000
    v_mov_b32 v182, 0xff800000
    v_mov_b32 v183, 0xff800000
    v_mov_b32 v184, 0xff800000
    v_mov_b32 v185, 0xff800000
    v_mov_b32 v186, 0xff800000
    v_mov_b32 v187, 0xff800000
    v_mov_b32 v188, 0xff800000
    v_mov_b32 v189, 0xff800000
    v_mov_b32 v190, 0xff800000
    v_mov_b32 v191, 0xff800000
    s_branch sequential_preLN__sliding_block__mixer_token_mlp__prompt_kernel_back27
sequential_preLN__sliding_block__mixer_token_mlp__prompt_kernel_nonC1:
    s_sub_u32 s50, s28, 28
    s_lshl_b32 s50, s50, 2
    s_add_u32 s50, s50, s3
    s_and_b32 s51, s27, 1
    s_mul_i32 s51, s51, 448
    s_add_u32 s50, s50, s51
    s_lshl_b32 s50, s50, 12
    s_lshl_b32 s51, s23, 10
    s_add_u32 s50, s50, s51
    s_mov_b32 s36, s16
    s_mov_b32 s37, s17
    s_mov_b32 s38, 7340032
    s_mov_b32 s39, 0x20000
    s_waitcnt vmcnt(0) lgkmcnt(0)
    s_add_u32 s51, s50, 0
    buffer_load_dwordx4 v[16:19], v2, s[36:39], s51 offen
    s_add_u32 s51, s50, 3670016
    buffer_load_dwordx4 v[16:19], v2, s[36:39], s51 offen
    s_add_u32 s51, s50, 65536
    buffer_load_dwordx4 v[16:19], v2, s[36:39], s51 offen
    s_add_u32 s51, s50, 3735552
    buffer_load_dwordx4 v[16:19], v2, s[36:39], s51 offen
    s_add_u32 s51, s50, 131072
    buffer_load_dwordx4 v[16:19], v2, s[36:39], s51 offen
    s_add_u32 s51, s50, 3801088
    buffer_load_dwordx4 v[16:19], v2, s[36:39], s51 offen
    s_add_u32 s51, s50, 196608
    buffer_load_dwordx4 v[16:19], v2, s[36:39], s51 offen
    s_add_u32 s51, s50, 3866624
    buffer_load_dwordx4 v[16:19], v2, s[36:39], s51 offen
    s_add_u32 s51, s50, 262144
    buffer_load_dwordx4 v[16:19], v2, s[36:39], s51 offen
    s_add_u32 s51, s50, 3932160
    buffer_load_dwordx4 v[16:19], v2, s[36:39], s51 offen
    s_add_u32 s51, s50, 327680
    buffer_load_dwordx4 v[16:19], v2, s[36:39], s51 offen
    s_add_u32 s51, s50, 3997696
    buffer_load_dwordx4 v[16:19], v2, s[36:39], s51 offen
    s_add_u32 s51, s50, 393216
    buffer_load_dwordx4 v[16:19], v2, s[36:39], s51 offen
    s_add_u32 s51, s50, 4063232
    buffer_load_dwordx4 v[16:19], v2, s[36:39], s51 offen
    s_add_u32 s51, s50, 458752
    buffer_load_dwordx4 v[16:19], v2, s[36:39], s51 offen
    s_add_u32 s51, s50, 4128768
    buffer_load_dwordx4 v[16:19], v2, s[36:39], s51 offen
    s_add_u32 s51, s50, 524288
    buffer_load_dwordx4 v[16:19], v2, s[36:39], s51 offen
    s_add_u32 s51, s50, 4194304
    buffer_load_dwordx4 v[16:19], v2, s[36:39], s51 offen
    s_add_u32 s51, s50, 589824
    buffer_load_dwordx4 v[16:19], v2, s[36:39], s51 offen
    s_add_u32 s51, s50, 4259840
    buffer_load_dwordx4 v[16:19], v2, s[36:39], s51 offen
    s_add_u32 s51, s50, 655360
    buffer_load_dwordx4 v[16:19], v2, s[36:39], s51 offen
    s_add_u32 s51, s50, 4325376
    buffer_load_dwordx4 v[16:19], v2, s[36:39], s51 offen
    s_add_u32 s51, s50, 720896
    buffer_load_dwordx4 v[16:19], v2, s[36:39], s51 offen
    s_add_u32 s51, s50, 4390912
    buffer_load_dwordx4 v[16:19], v2, s[36:39], s51 offen
    s_add_u32 s51, s50, 786432
    buffer_load_dwordx4 v[16:19], v2, s[36:39], s51 offen
    s_add_u32 s51, s50, 4456448
    buffer_load_dwordx4 v[16:19], v2, s[36:39], s51 offen
    s_add_u32 s51, s50, 851968
    buffer_load_dwordx4 v[16:19], v2, s[36:39], s51 offen
    s_add_u32 s51, s50, 4521984
    buffer_load_dwordx4 v[16:19], v2, s[36:39], s51 offen
    s_add_u32 s51, s50, 917504
    buffer_load_dwordx4 v[16:19], v2, s[36:39], s51 offen
    s_add_u32 s51, s50, 4587520
    buffer_load_dwordx4 v[16:19], v2, s[36:39], s51 offen
    s_add_u32 s51, s50, 983040
    buffer_load_dwordx4 v[16:19], v2, s[36:39], s51 offen
    s_add_u32 s51, s50, 4653056
    buffer_load_dwordx4 v[16:19], v2, s[36:39], s51 offen
    s_add_u32 s51, s50, 1048576
    buffer_load_dwordx4 v[16:19], v2, s[36:39], s51 offen
    s_add_u32 s51, s50, 4718592
    buffer_load_dwordx4 v[16:19], v2, s[36:39], s51 offen
    s_add_u32 s51, s50, 1114112
    buffer_load_dwordx4 v[16:19], v2, s[36:39], s51 offen
    s_add_u32 s51, s50, 4784128
    buffer_load_dwordx4 v[16:19], v2, s[36:39], s51 offen
    s_add_u32 s51, s50, 1179648
    buffer_load_dwordx4 v[16:19], v2, s[36:39], s51 offen
    s_add_u32 s51, s50, 4849664
    buffer_load_dwordx4 v[16:19], v2, s[36:39], s51 offen
    s_add_u32 s51, s50, 1245184
    buffer_load_dwordx4 v[16:19], v2, s[36:39], s51 offen
    s_add_u32 s51, s50, 4915200
    buffer_load_dwordx4 v[16:19], v2, s[36:39], s51 offen
    s_add_u32 s51, s50, 1310720
    buffer_load_dwordx4 v[16:19], v2, s[36:39], s51 offen
    s_add_u32 s51, s50, 4980736
    buffer_load_dwordx4 v[16:19], v2, s[36:39], s51 offen
    s_add_u32 s51, s50, 1376256
    buffer_load_dwordx4 v[16:19], v2, s[36:39], s51 offen
    s_add_u32 s51, s50, 5046272
    buffer_load_dwordx4 v[16:19], v2, s[36:39], s51 offen
    s_add_u32 s51, s50, 1441792
    buffer_load_dwordx4 v[16:19], v2, s[36:39], s51 offen
    s_add_u32 s51, s50, 5111808
    buffer_load_dwordx4 v[16:19], v2, s[36:39], s51 offen
    s_add_u32 s51, s50, 1507328
    buffer_load_dwordx4 v[16:19], v2, s[36:39], s51 offen
    s_add_u32 s51, s50, 5177344
    buffer_load_dwordx4 v[16:19], v2, s[36:39], s51 offen
    s_add_u32 s51, s50, 1572864
    buffer_load_dwordx4 v[16:19], v2, s[36:39], s51 offen
    s_add_u32 s51, s50, 5242880
    buffer_load_dwordx4 v[16:19], v2, s[36:39], s51 offen
    s_add_u32 s51, s50, 1638400
    buffer_load_dwordx4 v[16:19], v2, s[36:39], s51 offen
    s_add_u32 s51, s50, 5308416
    buffer_load_dwordx4 v[16:19], v2, s[36:39], s51 offen
    s_add_u32 s51, s50, 1703936
    buffer_load_dwordx4 v[16:19], v2, s[36:39], s51 offen
    s_add_u32 s51, s50, 5373952
    buffer_load_dwordx4 v[16:19], v2, s[36:39], s51 offen
    s_add_u32 s51, s50, 1769472
    buffer_load_dwordx4 v[16:19], v2, s[36:39], s51 offen
    s_add_u32 s51, s50, 5439488
    buffer_load_dwordx4 v[16:19], v2, s[36:39], s51 offen
    s_mul_i32 s96, s3, 28672
    s_lshl_b32 s67, s23, 3
    s_add_u32 s67, s67, s10
    s_mul_i32 s50, s3, 1835008
    s_lshl_b32 s51, s67, 7
    s_add_u32 s50, s50, s51
    s_sub_u32 s51, 7340032, s50
    s_add_u32 s44, s16, s50
    s_addc_u32 s45, s17, 0
    s_mov_b32 s46, s51
    s_mov_b32 s47, 0x20000
    v_lshrrev_b32 v3, 3, v1
    v_mul_u32_u24 v3, 4096, v3
    v_and_b32 v4, 7, v1
    v_bfe_u32 v5, v1, 4, 1
    v_lshlrev_b32 v5, 2, v5
    v_xor_b32 v4, v4, v5
    v_lshl_add_u32 v244, v4, 4, v3
    v_add_u32 v245, 31744, v244
    v_lshrrev_b32 v3, 5, v1
    v_bfe_u32 v4, v1, 2, 2
    v_lshl_add_u32 v4, v3, 2, v4
    v_lshlrev_b32 v4, 7, v4
    v_bfe_u32 v5, v1, 4, 1
    v_lshl_add_u32 v4, v5, 5, v4
    v_and_b32 v5, 3, v1
    v_lshl_add_u32 v4, v5, 3, v4
    v_add_u32 v4, s96, v4
    v_bfe_u32 v5, v1, 3, 1
    v_xor_b32 v5, s55, v5
    v_lshl_add_u32 v240, v5, 6, v4
    v_xor_b32 v5, 1, v5
    v_lshl_add_u32 v241, v5, 6, v4
sequential_preLN__sliding_block__mixer_token_mlp__prompt_kernel_nonD2:
    s_cmp_ge_u32 s10, 8
    s_cbranch_scc1 sequential_preLN__sliding_block__mixer_token_mlp__prompt_kernel_fin4
    s_waitcnt vmcnt(0) lgkmcnt(0)
    s_add_u32 m0, s96, 0
    s_mov_b32 s48, 0
    buffer_load_dwordx4 v244, s[44:47], s48 offen lds
    buffer_load_dwordx4 v245, s[44:47], s48 offen offset:1024 lds
    s_add_u32 m0, s96, 2048
    s_mov_b32 s48, 65536
    buffer_load_dwordx4 v244, s[44:47], s48 offen lds
    buffer_load_dwordx4 v245, s[44:47], s48 offen offset:1024 lds
    s_add_u32 m0, s96, 4096
    s_mov_b32 s48, 131072
    buffer_load_dwordx4 v244, s[44:47], s48 offen lds
    buffer_load_dwordx4 v245, s[44:47], s48 offen offset:1024 lds
    s_add_u32 m0, s96, 6144
    s_mov_b32 s48, 196608
    buffer_load_dwordx4 v244, s[44:47], s48 offen lds
    buffer_load_dwordx4 v245, s[44:47], s48 offen offset:1024 lds
    s_add_u32 m0, s96, 8192
    s_mov_b32 s48, 262144
    buffer_load_dwordx4 v244, s[44:47], s48 offen lds
    buffer_load_dwordx4 v245, s[44:47], s48 offen offset:1024 lds
    s_add_u32 m0, s96, 10240
    s_mov_b32 s48, 327680
    buffer_load_dwordx4 v244, s[44:47], s48 offen lds
    buffer_load_dwordx4 v245, s[44:47], s48 offen offset:1024 lds
    s_add_u32 m0, s96, 12288
    s_mov_b32 s48, 393216
    buffer_load_dwordx4 v244, s[44:47], s48 offen lds
    buffer_load_dwordx4 v245, s[44:47], s48 offen offset:1024 lds
    s_add_u32 m0, s96, 14336
    s_mov_b32 s48, 458752
    buffer_load_dwordx4 v244, s[44:47], s48 offen lds
    buffer_load_dwordx4 v245, s[44:47], s48 offen offset:1024 lds
    s_add_u32 m0, s96, 16384
    s_mov_b32 s48, 524288
    buffer_load_dwordx4 v244, s[44:47], s48 offen lds
    buffer_load_dwordx4 v245, s[44:47], s48 offen offset:1024 lds
    s_add_u32 m0, s96, 18432
    s_mov_b32 s48, 589824
    buffer_load_dwordx4 v244, s[44:47], s48 offen lds
    buffer_load_dwordx4 v245, s[44:47], s48 offen offset:1024 lds
    s_add_u32 m0, s96, 20480
    s_mov_b32 s48, 655360
    buffer_load_dwordx4 v244, s[44:47], s48 offen lds
    buffer_load_dwordx4 v245, s[44:47], s48 offen offset:1024 lds
    s_add_u32 m0, s96, 22528
    s_mov_b32 s48, 720896
    buffer_load_dwordx4 v244, s[44:47], s48 offen lds
    buffer_load_dwordx4 v245, s[44:47], s48 offen offset:1024 lds
    s_add_u32 m0, s96, 24576
    s_mov_b32 s48, 786432
    buffer_load_dwordx4 v244, s[44:47], s48 offen lds
    buffer_load_dwordx4 v245, s[44:47], s48 offen offset:1024 lds
    s_add_u32 m0, s96, 26624
    s_mov_b32 s48, 851968
    buffer_load_dwordx4 v244, s[44:47], s48 offen lds
    buffer_load_dwordx4 v245, s[44:47], s48 offen offset:1024 lds
    s_waitcnt vmcnt(26)
    ds_read_b64_tr_b16 a[0:1], v240 offset:0
    ds_read_b64_tr_b16 a[2:3], v240 offset:1024
    ds_read_b64_tr_b16 a[4:5], v241 offset:0
    ds_read_b64_tr_b16 a[6:7], v241 offset:1024
    s_waitcnt vmcnt(24)
    ds_read_b64_tr_b16 a[8:9], v240 offset:2048
    ds_read_b64_tr_b16 a[10:11], v240 offset:3072
    ds_read_b64_tr_b16 a[12:13], v241 offset:2048
    ds_read_b64_tr_b16 a[14:15], v241 offset:3072
    s_waitcnt vmcnt(22)
    ds_read_b64_tr_b16 a[16:17], v240 offset:4096
    ds_read_b64_tr_b16 a[18:19], v240 offset:5120
    ds_read_b64_tr_b16 a[20:21], v241 offset:4096
    ds_read_b64_tr_b16 a[22:23], v241 offset:5120
    s_waitcnt vmcnt(20)
    ds_read_b64_tr_b16 a[24:25], v240 offset:6144
    ds_read_b64_tr_b16 a[26:27], v240 offset:7168
    ds_read_b64_tr_b16 a[28:29], v241 offset:6144
    ds_read_b64_tr_b16 a[30:31], v241 offset:7168
    s_waitcnt vmcnt(18)
    ds_read_b64_tr_b16 a[32:33], v240 offset:8192
    ds_read_b64_tr_b16 a[34:35], v240 offset:9216
    ds_read_b64_tr_b16 a[36:37], v241 offset:8192
    ds_read_b64_tr_b16 a[38:39], v241 offset:9216
    s_waitcnt vmcnt(16)
    ds_read_b64_tr_b16 a[40:41], v240 offset:10240
    ds_read_b64_tr_b16 a[42:43], v240 offset:11264
    ds_read_b64_tr_b16 a[44:45], v241 offset:10240
    ds_read_b64_tr_b16 a[46:47], v241 offset:11264
    s_waitcnt vmcnt(14)
    ds_read_b64_tr_b16 a[48:49], v240 offset:12288
    ds_read_b64_tr_b16 a[50:51], v240 offset:13312
    ds_read_b64_tr_b16 a[52:53], v241 offset:12288
    ds_read_b64_tr_b16 a[54:55], v241 offset:13312
    s_waitcnt vmcnt(12)
    ds_read_b64_tr_b16 a[56:57], v240 offset:14336
    ds_read_b64_tr_b16 a[58:59], v240 offset:15360
    ds_read_b64_tr_b16 a[60:61], v241 offset:14336
    ds_read_b64_tr_b16 a[62:63], v241 offset:15360
    s_waitcnt vmcnt(10)
    ds_read_b64_tr_b16 a[64:65], v240 offset:16384
    ds_read_b64_tr_b16 a[66:67], v240 offset:17408
    ds_read_b64_tr_b16 a[68:69], v241 offset:16384
    ds_read_b64_tr_b16 a[70:71], v241 offset:17408
    s_waitcnt vmcnt(8)
    ds_read_b64_tr_b16 a[72:73], v240 offset:18432
    ds_read_b64_tr_b16 a[74:75], v240 offset:19456
    ds_read_b64_tr_b16 a[76:77], v241 offset:18432
    ds_read_b64_tr_b16 a[78:79], v241 offset:19456
    s_waitcnt vmcnt(6)
    ds_read_b64_tr_b16 a[80:81], v240 offset:20480
    ds_read_b64_tr_b16 a[82:83], v240 offset:21504
    ds_read_b64_tr_b16 a[84:85], v241 offset:20480
    ds_read_b64_tr_b16 a[86:87], v241 offset:21504
    s_waitcnt vmcnt(4)
    ds_read_b64_tr_b16 a[88:89], v240 offset:22528
    ds_read_b64_tr_b16 a[90:91], v240 offset:23552
    ds_read_b64_tr_b16 a[92:93], v241 offset:22528
    ds_read_b64_tr_b16 a[94:95], v241 offset:23552
    s_waitcnt vmcnt(2)
    ds_read_b64_tr_b16 a[96:97], v240 offset:24576
    ds_read_b64_tr_b16 a[98:99], v240 offset:25600
    ds_read_b64_tr_b16 a[100:101], v241 offset:24576
    ds_read_b64_tr_b16 a[102:103], v241 offset:25600
    s_waitcnt vmcnt(0)
    ds_read_b64_tr_b16 a[104:105], v240 offset:26624
    ds_read_b64_tr_b16 a[106:107], v240 offset:27648
    ds_read_b64_tr_b16 a[108:109], v241 offset:26624
    ds_read_b64_tr_b16 a[110:111], v241 offset:27648
    s_mul_i32 s66, s22, 14336
    s_mul_i32 s50, s3, 3584
    s_add_u32 s66, s66, s50
    s_add_u32 s66, s66, 1441792
    v_and_b32 v6, 31, v1
    v_min_u32 v6, 27, v6
    v_lshlrev_b32 v6, 7, v6
    s_waitcnt lgkmcnt(0)
    s_add_u32 m0, s96, 0
    s_mov_b32 s48, 917504
    buffer_load_dwordx4 v244, s[44:47], s48 offen lds
    buffer_load_dwordx4 v245, s[44:47], s48 offen offset:1024 lds
    s_add_u32 m0, s96, 2048
    s_mov_b32 s48, 983040
    buffer_load_dwordx4 v244, s[44:47], s48 offen lds
    buffer_load_dwordx4 v245, s[44:47], s48 offen offset:1024 lds
    s_add_u32 m0, s96, 4096
    s_mov_b32 s48, 1048576
    buffer_load_dwordx4 v244, s[44:47], s48 offen lds
    buffer_load_dwordx4 v245, s[44:47], s48 offen offset:1024 lds
    s_add_u32 m0, s96, 6144
    s_mov_b32 s48, 1114112
    buffer_load_dwordx4 v244, s[44:47], s48 offen lds
    buffer_load_dwordx4 v245, s[44:47], s48 offen offset:1024 lds
    s_add_u32 m0, s96, 8192
    s_mov_b32 s48, 1179648
    buffer_load_dwordx4 v244, s[44:47], s48 offen lds
    buffer_load_dwordx4 v245, s[44:47], s48 offen offset:1024 lds
    s_add_u32 m0, s96, 10240
    s_mov_b32 s48, 1245184
    buffer_load_dwordx4 v244, s[44:47], s48 offen lds
    buffer_load_dwordx4 v245, s[44:47], s48 offen offset:1024 lds
    s_add_u32 m0, s96, 12288
    s_mov_b32 s48, 1310720
    buffer_load_dwordx4 v244, s[44:47], s48 offen lds
    buffer_load_dwordx4 v245, s[44:47], s48 offen offset:1024 lds
    s_add_u32 m0, s96, 14336
    s_mov_b32 s48, 1376256
    buffer_load_dwordx4 v244, s[44:47], s48 offen lds
    buffer_load_dwordx4 v245, s[44:47], s48 offen offset:1024 lds
    s_add_u32 m0, s96, 16384
    s_mov_b32 s48, 1441792
    buffer_load_dwordx4 v244, s[44:47], s48 offen lds
    buffer_load_dwordx4 v245, s[44:47], s48 offen offset:1024 lds
    s_add_u32 m0, s96, 18432
    s_mov_b32 s48, 1507328
    buffer_load_dwordx4 v244, s[44:47], s48 offen lds
    buffer_load_dwordx4 v245, s[44:47], s48 offen offset:1024 lds
    s_add_u32 m0, s96, 20480
    s_mov_b32 s48, 1572864
    buffer_load_dwordx4 v244, s[44:47], s48 offen lds
    buffer_load_dwordx4 v245, s[44:47], s48 offen offset:1024 lds
    s_add_u32 m0, s96, 22528
    s_mov_b32 s48, 1638400
    buffer_load_dwordx4 v244, s[44:47], s48 offen lds
    buffer_load_dwordx4 v245, s[44:47], s48 offen offset:1024 lds
    s_add_u32 m0, s96, 24576
    s_mov_b32 s48, 1703936
    buffer_load_dwordx4 v244, s[44:47], s48 offen lds
    buffer_load_dwordx4 v245, s[44:47], s48 offen offset:1024 lds
    s_add_u32 m0, s96, 26624
    s_mov_b32 s48, 1769472
    buffer_load_dwordx4 v244, s[44:47], s48 offen lds
    buffer_load_dwordx4 v245, s[44:47], s48 offen offset:1024 lds
    s_lshr_b32 s56, s3, 1
    s_branch sequential_preLN__sliding_block__mixer_token_mlp__prompt_kernel_joinE3
.section .rodata,"a"
.p2align 6
.amdhsa_kernel sequential_preLN__sliding_block__mixer_token_mlp__prompt_kernel
  .amdhsa_next_free_vgpr 512
  .amdhsa_next_free_sgpr 102
  .amdhsa_accum_offset 256
  .amdhsa_group_segment_fixed_size 0
  .amdhsa_kernarg_size 88
  .amdhsa_user_sgpr_count 2
  .amdhsa_user_sgpr_kernarg_segment_ptr 1
  .amdhsa_system_sgpr_workgroup_id_x 1
  .amdhsa_float_denorm_mode_32 3
.end_amdhsa_kernel
```
